```python
import torch

def _softmax(x, axis=-1):
    return torch.softmax(x, dim=axis)
def _gelu(x):
    return torch.nn.functional.gelu(x, approximate="tanh")
def _silu(x):
    return torch.nn.functional.silu(x)
def _sigmoid(x):
    return torch.sigmoid(x)
def _layernorm(x, axis=-1, eps=1e-5):
    m = x.mean(dim=axis, keepdim=True)
    v = x.var(dim=axis, keepdim=True, unbiased=False)
    return (x - m) / torch.sqrt(v + eps)
def _scatter_add(tgt, idx, src, axis=0):
    return tgt.clone().index_add_(axis, idx, src)
def _segment_sum(src, seg, n):
    out = torch.zeros((n,) + src.shape[1:], dtype=src.dtype)
    return out.index_add_(0, seg, src)
def _pad(x, pw):
    flat = tuple(v for pair in reversed(pw) for v in pair)
    return torch.nn.functional.pad(x, flat)

kernel_name = 'gated_mix__grouped_kv_mqa__mixer_s_mlp__prompt'

def setup_inputs():

    _w = (lambda a: (lambda t: t.to(torch.bfloat16) if t.is_floating_point() else t)(torch.as_tensor(a)))
    def _A_setup():
        B, S, D, H = 1, 2048, 640, 32
        Dh = D // H
        return {
            "x": _w((lambda *s: torch.randn(*s, dtype=torch.bfloat16) * 0.05)(B, S, D)),
            "wq": _w((lambda *s: torch.randn(*s, dtype=torch.bfloat16) * 0.8)(D, H * Dh)),
            "wk": _w((lambda *s: torch.randn(*s, dtype=torch.bfloat16) * 0.8)(D, Dh)),
            "wv": _w((lambda *s: torch.randn(*s, dtype=torch.bfloat16) * 1.6)(D, Dh)),
            "wo": _w((lambda *s: torch.randn(*s, dtype=torch.bfloat16) * 1.6)(H * Dh, D)),
        }
    _A_in = _A_setup()

    def _B_setup():
        B, S, D, F = 1, 2048, 640, 1728
        return {
            "x":  _w((lambda *s: torch.randn(*s, dtype=torch.bfloat16) * 0.05)(B, S, D)),
            "w1": _w((lambda *s: torch.randn(*s, dtype=torch.bfloat16) * 3.2)(D, D) * (D ** -0.5)),
            "w2": _w((lambda *s: torch.randn(*s, dtype=torch.bfloat16) * 3.2)(D, D) * (D ** -0.5)),
            "w3": _w((lambda *s: torch.randn(*s, dtype=torch.bfloat16) * 3.2)(D, F) * (D ** -0.5)),
            "w4": _w((lambda *s: torch.randn(*s, dtype=torch.bfloat16) * 1.6)(F, D) * (F ** -0.5)),
        }
    _B_in = _B_setup()

    return {
        "A_x": _A_in["x"],
        "A_wq": _A_in["wq"],
        "A_wk": _A_in["wk"],
        "A_wv": _A_in["wv"],
        "A_wo": _A_in["wo"],
        "B_x": _B_in["x"],
        "B_w1": _B_in["w1"],
        "B_w2": _B_in["w2"],
        "B_w3": _B_in["w3"],
        "B_w4": _B_in["w4"],
        "gate_w": _w((lambda *s: torch.randn(*s, dtype=torch.bfloat16) * 0.1)(640) * 16.0),
    }

def reference(A_x, A_wq, A_wk, A_wv, A_wo, B_x, B_w1, B_w2, B_w3, B_w4, gate_w):
    def _A_ref(x, wq, wk, wv, wo):
        B, S, D = x.shape
        H = 32
        Dh = D // H
        q = (lambda x, *d: x.permute(*d))((x @ wq).reshape(B, S, H, Dh), 0, 2, 1, 3)
        k = x @ wk
        v = x @ wv
        scores = torch.einsum("bhqd,bkd->bhqk", q, k) * (Dh ** -0.5)
        p = _softmax(scores, axis=-1)
        o = torch.einsum("bhqk,bkd->bhqd", p, v)
        return (lambda x, *d: x.permute(*d))(o, 0, 2, 1, 3).reshape(B, S, H * Dh) @ wo

    def _B_ref(x, w1, w2, w3, w4):
        B, S, D = x.shape
        h = _gelu(_layernorm(x, axis=-1) @ w1)
        c = D // 4
        g0 = _pad(h[:, :, 0*c:1*c], ((0, 0), (1, 0), (0, 0)))[:, :S, :]
        g1 = _pad(h[:, :, 1*c:2*c], ((0, 0), (0, 1), (0, 0)))[:, 1:, :]
        g2 = _pad(h[:, :, 2*c:3*c], ((0, 0), (2, 0), (0, 0)))[:, :S, :]
        g3 = _pad(h[:, :, 3*c:   ], ((0, 0), (0, 2), (0, 0)))[:, 2:, :]
        hs = torch.concatenate([g0, g1, g2, g3], axis=-1) @ w2
        x1 = x + hs
        h2 = _gelu(_layernorm(x1, axis=-1) @ w3) @ w4
        return x1 + h2

    x = A_x
    g = _sigmoid((x * gate_w).sum(-1, keepdims=True))
    a = _A_ref(x, A_wq, A_wk, A_wv, A_wo)
    b = _B_ref(x, B_w1, B_w2, B_w3, B_w4)
    return g * a + (1 - g) * b
```

```asm
; @launch kernel=front_kernel grid=(256,1,1) block=(512,1,1) lds=155648
; @launch kernel=main_kernel grid=(512,1,1) block=(256,1,1) lds=81920
.amdgcn_target "amdgcn-amd-amdhsa--gfx950"
.text
.globl front_kernel
.p2align 8
.type front_kernel,@function
front_kernel:
  s_cmp_ge_u32 s2, 256
  s_cbranch_scc1 front_kernel_end
  s_getpc_b64 s[36:37]
front_kernel_cp:
  s_sub_u32 s36, s36, front_kernel_cp-front_kernel
  s_subb_u32 s37, s37, 0
  v_lshlrev_b32 v6, 7, v0
  v_cmp_gt_u32 vcc, code_end-front_kernel, v6
  s_and_saveexec_b64 s[38:39], vcc
  s_cbranch_execz front_kernel_cp1
  global_load_dword v222, v6, s[36:37]
front_kernel_cp1:
  s_mov_b64 exec, s[38:39]
  s_load_dwordx2 s[6:7], s[0:1], 0
  s_load_dwordx2 s[8:9], s[0:1], 8
  s_load_dwordx2 s[10:11], s[0:1], 48
  s_load_dwordx2 s[12:13], s[0:1], 16
  s_load_dwordx2 s[14:15], s[0:1], 24
  s_load_dwordx2 s[18:19], s[0:1], 80
  s_load_dwordx2 s[4:5], s[0:1], 104
  s_load_dwordx2 s[20:21], s[0:1], 56
  s_load_dwordx2 s[22:23], s[0:1], 32
  s_load_dwordx2 s[24:25], s[0:1], 64
  s_load_dwordx2 s[26:27], s[0:1], 72
  v_lshrrev_b32 v1, 6, v0
  v_and_b32 v2, 63, v0
  v_lshlrev_b32 v3, 4, v2
  v_readfirstlane_b32 s3, v1
  s_and_b32 s46, s2, 7
  s_lshr_b32 s47, s2, 3
  s_lshr_b32 s40, s46, 1
  s_lshl_b32 s40, s40, 3
  s_lshr_b32 s49, s47, 2
  s_add_u32 s40, s40, s49
  s_and_b32 s41, s46, 1
  s_lshl_b32 s41, s41, 2
  s_and_b32 s49, s47, 3
  s_add_u32 s41, s41, s49
  s_lshr_b32 s42, s41, 2
  s_and_b32 s43, s41, 3
  s_cmp_ge_u32 s3, 4
  s_cbranch_scc0 front_kernel_compute
  s_sub_u32 s3, s3, 4
  s_mul_i32 s46, s40, 3
  s_mul_i32 s47, s46, 6554
  s_lshr_b32 s47, s47, 16
  s_mul_i32 s47, s47, 10
  s_sub_u32 s48, s46, s47
  v_lshrrev_b32 v4, 3, v2
  v_and_b32 v5, 7, v2
  s_lshl_b32 s46, s3, 3
  v_add_u32 v6, s46, v4
  v_bfe_u32 v7, v6, 1, 3
  v_xor_b32 v7, v7, v5
  v_lshlrev_b32 v7, 4, v7
  s_lshl_b32 s47, s40, 6
  v_add_u32 v6, s47, v6
  v_mul_u32_u24 v6, 1280, v6
  v_add_u32 v200, v6, v7
  v_add_u32 v201, 40960, v200
  s_mov_b32 s50, 13421773
  s_mul_i32 s51, s43, 320
  s_add_u32 s46, s3, 0
  s_lshl_b32 s46, s46, 10
  v_add_u32 v6, s46, v3
  v_mul_hi_u32 v7, v6, s50
  v_mul_u32_u24 v8, 320, v7
  v_sub_u32 v8, v6, v8
  v_bfe_u32 v10, v7, 2, 1
  v_and_b32 v9, 0x33, v7
  v_lshl_or_b32 v9, v10, 3, v9
  v_bfe_u32 v11, v7, 3, 1
  v_lshl_or_b32 v9, v11, 2, v9
  v_lshlrev_b32 v10, 5, v10
  v_xor_b32 v8, v8, v10
  v_mul_u32_u24 v9, 1280, v9
  v_add_u32 v9, v9, v8
  v_add_u32 v202, s51, v9
  s_add_u32 s46, s3, 4
  s_lshl_b32 s46, s46, 10
  v_add_u32 v6, s46, v3
  v_mul_hi_u32 v7, v6, s50
  v_mul_u32_u24 v8, 320, v7
  v_sub_u32 v8, v6, v8
  v_bfe_u32 v10, v7, 2, 1
  v_and_b32 v9, 0x33, v7
  v_lshl_or_b32 v9, v10, 3, v9
  v_bfe_u32 v11, v7, 3, 1
  v_lshl_or_b32 v9, v11, 2, v9
  v_lshlrev_b32 v10, 5, v10
  v_xor_b32 v8, v8, v10
  v_mul_u32_u24 v9, 1280, v9
  v_add_u32 v9, v9, v8
  v_add_u32 v203, s51, v9
  s_add_u32 s46, s3, 8
  s_lshl_b32 s46, s46, 10
  v_add_u32 v6, s46, v3
  v_mul_hi_u32 v7, v6, s50
  v_mul_u32_u24 v8, 320, v7
  v_sub_u32 v8, v6, v8
  v_bfe_u32 v10, v7, 2, 1
  v_and_b32 v9, 0x33, v7
  v_lshl_or_b32 v9, v10, 3, v9
  v_bfe_u32 v11, v7, 3, 1
  v_lshl_or_b32 v9, v11, 2, v9
  v_lshlrev_b32 v10, 5, v10
  v_xor_b32 v8, v8, v10
  v_mul_u32_u24 v9, 1280, v9
  v_add_u32 v9, v9, v8
  v_add_u32 v204, s51, v9
  s_add_u32 s46, s3, 12
  s_lshl_b32 s46, s46, 10
  v_add_u32 v6, s46, v3
  v_mul_hi_u32 v7, v6, s50
  v_mul_u32_u24 v8, 320, v7
  v_sub_u32 v8, v6, v8
  v_bfe_u32 v10, v7, 2, 1
  v_and_b32 v9, 0x33, v7
  v_lshl_or_b32 v9, v10, 3, v9
  v_bfe_u32 v11, v7, 3, 1
  v_lshl_or_b32 v9, v11, 2, v9
  v_lshlrev_b32 v10, 5, v10
  v_xor_b32 v8, v8, v10
  v_mul_u32_u24 v9, 1280, v9
  v_add_u32 v9, v9, v8
  v_add_u32 v205, s51, v9
  s_add_u32 s46, s3, 16
  s_lshl_b32 s46, s46, 10
  v_add_u32 v6, s46, v3
  v_mul_hi_u32 v7, v6, s50
  v_mul_u32_u24 v8, 320, v7
  v_sub_u32 v8, v6, v8
  v_bfe_u32 v10, v7, 2, 1
  v_and_b32 v9, 0x33, v7
  v_lshl_or_b32 v9, v10, 3, v9
  v_bfe_u32 v11, v7, 3, 1
  v_lshl_or_b32 v9, v11, 2, v9
  v_lshlrev_b32 v10, 5, v10
  v_xor_b32 v8, v8, v10
  v_mul_u32_u24 v9, 1280, v9
  v_add_u32 v9, v9, v8
  v_add_u32 v206, s51, v9
  s_lshl_b32 s46, s3, 10
  v_add_u32 v6, s46, v3
  v_mov_b32 v7, 2130706432
  v_cmp_gt_u32 vcc, 2560, v6
  s_nop 1
  v_cndmask_b32 v6, v7, v6, vcc
  v_cmp_gt_u32 vcc, 128, v3
  s_nop 1
  v_cndmask_b32 v8, v7, v3, vcc
  s_cmp_eq_u32 s3, 3
  s_cselect_b64 vcc, -1, 0
  v_cndmask_b32 v207, v6, v8, vcc
  s_waitcnt lgkmcnt(0)
  s_mov_b32 s28, s6
  s_mov_b32 s29, s7
  s_mov_b32 s30, 2621440
  s_mov_b32 s31, 0x20000
  s_cmp_eq_u32 s42, 0
  s_cselect_b32 s32, s8, s10
  s_cselect_b32 s33, s9, s11
  s_mov_b32 s34, 819200
  s_mov_b32 s35, 0x20000
  s_cselect_b32 s52, s12, s14
  s_cselect_b32 s53, s13, s15
  s_mov_b32 s54, 25600
  s_mov_b32 s55, 0x20000
  s_cmp_eq_u32 s3, 3
  s_cselect_b32 s52, s18, s52
  s_cselect_b32 s53, s19, s53
  s_cselect_b32 s54, 1280, s54
  s_mov_b32 s46, 2560
  s_cselect_b32 s70, 128, s46
  s_lshl_b32 s46, s3, 10
  s_add_u32 s71, s46, 28672
  s_lshl_b32 s72, s3, 10
  s_lshr_b32 s46, s2, 3
  s_mul_i32 s46, s46, 200
  s_mul_i32 s47, s3, 50
  s_add_u32 s46, s46, s47
  s_lshl_b32 s46, s46, 7
  v_lshlrev_b32 v6, 7, v2
  v_mov_b32 v7, 2130706432
  v_cmp_gt_u32 vcc, 50, v2
  s_nop 1
  v_cndmask_b32 v6, v7, v6, vcc
  buffer_load_dword v20, v6, s[32:35], s46 offen
  s_lshl_b32 s46, s40, 6
  s_lshl_b32 s47, s43, 4
  s_add_u32 s46, s46, s47
  s_lshl_b32 s47, s3, 2
  s_add_u32 s46, s46, s47
  s_mul_i32 s46, s46, 1280
  v_lshlrev_b32 v6, 7, v2
  v_cmp_gt_u32 vcc, 40, v2
  s_nop 1
  v_cndmask_b32 v6, v7, v6, vcc
  buffer_load_dword v21, v6, s[28:31], s46 offen
  s_lshl_b32 s74, s48, 7
  s_mul_i32 s75, s48, 81920
  s_mul_i32 s76, s48, s70
  s_add_u32 m0, s72, 0
  s_nop 0
  buffer_load_dwordx4 v200, s[28:31], s74 offen lds
  s_add_u32 m0, s72, 4096
  s_nop 0
  buffer_load_dwordx4 v201, s[28:31], s74 offen lds
  s_add_u32 m0, s72, 8192
  s_nop 0
  buffer_load_dwordx4 v202, s[32:35], s75 offen lds
  s_add_u32 m0, s72, 12288
  s_nop 0
  buffer_load_dwordx4 v203, s[32:35], s75 offen lds
  s_add_u32 m0, s72, 16384
  s_nop 0
  buffer_load_dwordx4 v204, s[32:35], s75 offen lds
  s_add_u32 m0, s72, 20480
  s_nop 0
  buffer_load_dwordx4 v205, s[32:35], s75 offen lds
  s_add_u32 m0, s72, 24576
  s_nop 0
  buffer_load_dwordx4 v206, s[32:35], s75 offen lds
  s_add_u32 m0, s71, 0
  s_nop 0
  buffer_load_dwordx4 v207, s[52:55], s76 offen lds
  s_add_u32 s48, s48, 1
  s_cmp_eq_u32 s48, 10
  s_cselect_b32 s48, 0, s48
  s_lshl_b32 s74, s48, 7
  s_mul_i32 s75, s48, 81920
  s_mul_i32 s76, s48, s70
  s_add_u32 m0, s72, 32768
  s_nop 0
  buffer_load_dwordx4 v200, s[28:31], s74 offen lds
  s_add_u32 m0, s72, 36864
  s_nop 0
  buffer_load_dwordx4 v201, s[28:31], s74 offen lds
  s_add_u32 m0, s72, 40960
  s_nop 0
  buffer_load_dwordx4 v202, s[32:35], s75 offen lds
  s_add_u32 m0, s72, 45056
  s_nop 0
  buffer_load_dwordx4 v203, s[32:35], s75 offen lds
  s_add_u32 m0, s72, 49152
  s_nop 0
  buffer_load_dwordx4 v204, s[32:35], s75 offen lds
  s_add_u32 m0, s72, 53248
  s_nop 0
  buffer_load_dwordx4 v205, s[32:35], s75 offen lds
  s_add_u32 m0, s72, 57344
  s_nop 0
  buffer_load_dwordx4 v206, s[32:35], s75 offen lds
  s_add_u32 m0, s71, 32768
  s_nop 0
  buffer_load_dwordx4 v207, s[52:55], s76 offen lds
  s_add_u32 s48, s48, 1
  s_cmp_eq_u32 s48, 10
  s_cselect_b32 s48, 0, s48
  v_lshrrev_b32 v14, 4, v2
  v_mov_b32 v96, 0x3f803f80
  v_mov_b32 v97, 0x3f803f80
  v_mov_b32 v98, 0x3f803f80
  v_mov_b32 v99, 0x3f803f80
  s_waitcnt vmcnt(8)
  s_barrier
  s_lshl_b32 s74, s48, 7
  s_mul_i32 s75, s48, 81920
  s_mul_i32 s76, s48, s70
  s_add_u32 m0, s72, 65536
  s_nop 0
  buffer_load_dwordx4 v200, s[28:31], s74 offen lds
  s_add_u32 m0, s72, 69632
  s_nop 0
  buffer_load_dwordx4 v201, s[28:31], s74 offen lds
  s_add_u32 m0, s72, 73728
  s_nop 0
  buffer_load_dwordx4 v202, s[32:35], s75 offen lds
  s_add_u32 m0, s72, 77824
  s_nop 0
  buffer_load_dwordx4 v203, s[32:35], s75 offen lds
  s_add_u32 m0, s72, 81920
  s_nop 0
  buffer_load_dwordx4 v204, s[32:35], s75 offen lds
  s_add_u32 m0, s72, 86016
  s_nop 0
  buffer_load_dwordx4 v205, s[32:35], s75 offen lds
  s_add_u32 m0, s72, 90112
  s_nop 0
  buffer_load_dwordx4 v206, s[32:35], s75 offen lds
  s_add_u32 m0, s71, 65536
  s_nop 0
  buffer_load_dwordx4 v207, s[52:55], s76 offen lds
  s_add_u32 s48, s48, 1
  s_cmp_eq_u32 s48, 10
  s_cselect_b32 s48, 0, s48
  s_lshl_b32 s74, s48, 7
  s_mul_i32 s75, s48, 81920
  s_mul_i32 s76, s48, s70
  s_add_u32 m0, s72, 98304
  s_nop 0
  buffer_load_dwordx4 v200, s[28:31], s74 offen lds
  s_add_u32 m0, s72, 102400
  s_nop 0
  buffer_load_dwordx4 v201, s[28:31], s74 offen lds
  s_add_u32 m0, s72, 106496
  s_nop 0
  buffer_load_dwordx4 v202, s[32:35], s75 offen lds
  s_add_u32 m0, s72, 110592
  s_nop 0
  buffer_load_dwordx4 v203, s[32:35], s75 offen lds
  s_add_u32 m0, s72, 114688
  s_nop 0
  buffer_load_dwordx4 v204, s[32:35], s75 offen lds
  s_add_u32 m0, s72, 118784
  s_nop 0
  buffer_load_dwordx4 v205, s[32:35], s75 offen lds
  s_add_u32 m0, s72, 122880
  s_nop 0
  buffer_load_dwordx4 v206, s[32:35], s75 offen lds
  s_add_u32 m0, s71, 98304
  s_nop 0
  buffer_load_dwordx4 v207, s[52:55], s76 offen lds
  s_add_u32 s48, s48, 1
  s_cmp_eq_u32 s48, 10
  s_cselect_b32 s48, 0, s48
  s_waitcnt vmcnt(16)
  s_barrier
  s_lshl_b32 s74, s48, 7
  s_mul_i32 s75, s48, 81920
  s_mul_i32 s76, s48, s70
  s_add_u32 m0, s72, 0
  s_nop 0
  buffer_load_dwordx4 v200, s[28:31], s74 offen lds
  s_add_u32 m0, s72, 4096
  s_nop 0
  buffer_load_dwordx4 v201, s[28:31], s74 offen lds
  s_add_u32 m0, s72, 8192
  s_nop 0
  buffer_load_dwordx4 v202, s[32:35], s75 offen lds
  s_add_u32 m0, s72, 12288
  s_nop 0
  buffer_load_dwordx4 v203, s[32:35], s75 offen lds
  s_add_u32 m0, s72, 16384
  s_nop 0
  buffer_load_dwordx4 v204, s[32:35], s75 offen lds
  s_add_u32 m0, s72, 20480
  s_nop 0
  buffer_load_dwordx4 v205, s[32:35], s75 offen lds
  s_add_u32 m0, s72, 24576
  s_nop 0
  buffer_load_dwordx4 v206, s[32:35], s75 offen lds
  s_add_u32 m0, s71, 0
  s_nop 0
  buffer_load_dwordx4 v207, s[52:55], s76 offen lds
  s_add_u32 s48, s48, 1
  s_cmp_eq_u32 s48, 10
  s_cselect_b32 s48, 0, s48
  s_waitcnt vmcnt(16)
  s_barrier
  s_lshl_b32 s74, s48, 7
  s_mul_i32 s75, s48, 81920
  s_mul_i32 s76, s48, s70
  s_add_u32 m0, s72, 32768
  s_nop 0
  buffer_load_dwordx4 v200, s[28:31], s74 offen lds
  s_add_u32 m0, s72, 36864
  s_nop 0
  buffer_load_dwordx4 v201, s[28:31], s74 offen lds
  s_add_u32 m0, s72, 40960
  s_nop 0
  buffer_load_dwordx4 v202, s[32:35], s75 offen lds
  s_add_u32 m0, s72, 45056
  s_nop 0
  buffer_load_dwordx4 v203, s[32:35], s75 offen lds
  s_add_u32 m0, s72, 49152
  s_nop 0
  buffer_load_dwordx4 v204, s[32:35], s75 offen lds
  s_add_u32 m0, s72, 53248
  s_nop 0
  buffer_load_dwordx4 v205, s[32:35], s75 offen lds
  s_add_u32 m0, s72, 57344
  s_nop 0
  buffer_load_dwordx4 v206, s[32:35], s75 offen lds
  s_add_u32 m0, s71, 32768
  s_nop 0
  buffer_load_dwordx4 v207, s[52:55], s76 offen lds
  s_add_u32 s48, s48, 1
  s_cmp_eq_u32 s48, 10
  s_cselect_b32 s48, 0, s48
  s_waitcnt vmcnt(16)
  s_barrier
  s_lshl_b32 s74, s48, 7
  s_mul_i32 s75, s48, 81920
  s_mul_i32 s76, s48, s70
  s_add_u32 m0, s72, 65536
  s_nop 0
  buffer_load_dwordx4 v200, s[28:31], s74 offen lds
  s_add_u32 m0, s72, 69632
  s_nop 0
  buffer_load_dwordx4 v201, s[28:31], s74 offen lds
  s_add_u32 m0, s72, 73728
  s_nop 0
  buffer_load_dwordx4 v202, s[32:35], s75 offen lds
  s_add_u32 m0, s72, 77824
  s_nop 0
  buffer_load_dwordx4 v203, s[32:35], s75 offen lds
  s_add_u32 m0, s72, 81920
  s_nop 0
  buffer_load_dwordx4 v204, s[32:35], s75 offen lds
  s_add_u32 m0, s72, 86016
  s_nop 0
  buffer_load_dwordx4 v205, s[32:35], s75 offen lds
  s_add_u32 m0, s72, 90112
  s_nop 0
  buffer_load_dwordx4 v206, s[32:35], s75 offen lds
  s_add_u32 m0, s71, 65536
  s_nop 0
  buffer_load_dwordx4 v207, s[52:55], s76 offen lds
  s_add_u32 s48, s48, 1
  s_cmp_eq_u32 s48, 10
  s_cselect_b32 s48, 0, s48
  s_waitcnt vmcnt(16)
  s_barrier
  s_lshl_b32 s74, s48, 7
  s_mul_i32 s75, s48, 81920
  s_mul_i32 s76, s48, s70
  s_add_u32 m0, s72, 98304
  s_nop 0
  buffer_load_dwordx4 v200, s[28:31], s74 offen lds
  s_add_u32 m0, s72, 102400
  s_nop 0
  buffer_load_dwordx4 v201, s[28:31], s74 offen lds
  s_add_u32 m0, s72, 106496
  s_nop 0
  buffer_load_dwordx4 v202, s[32:35], s75 offen lds
  s_add_u32 m0, s72, 110592
  s_nop 0
  buffer_load_dwordx4 v203, s[32:35], s75 offen lds
  s_add_u32 m0, s72, 114688
  s_nop 0
  buffer_load_dwordx4 v204, s[32:35], s75 offen lds
  s_add_u32 m0, s72, 118784
  s_nop 0
  buffer_load_dwordx4 v205, s[32:35], s75 offen lds
  s_add_u32 m0, s72, 122880
  s_nop 0
  buffer_load_dwordx4 v206, s[32:35], s75 offen lds
  s_add_u32 m0, s71, 98304
  s_nop 0
  buffer_load_dwordx4 v207, s[52:55], s76 offen lds
  s_add_u32 s48, s48, 1
  s_cmp_eq_u32 s48, 10
  s_cselect_b32 s48, 0, s48
  s_waitcnt vmcnt(16)
  s_barrier
  s_lshl_b32 s74, s48, 7
  s_mul_i32 s75, s48, 81920
  s_mul_i32 s76, s48, s70
  s_add_u32 m0, s72, 0
  s_nop 0
  buffer_load_dwordx4 v200, s[28:31], s74 offen lds
  s_add_u32 m0, s72, 4096
  s_nop 0
  buffer_load_dwordx4 v201, s[28:31], s74 offen lds
  s_add_u32 m0, s72, 8192
  s_nop 0
  buffer_load_dwordx4 v202, s[32:35], s75 offen lds
  s_add_u32 m0, s72, 12288
  s_nop 0
  buffer_load_dwordx4 v203, s[32:35], s75 offen lds
  s_add_u32 m0, s72, 16384
  s_nop 0
  buffer_load_dwordx4 v204, s[32:35], s75 offen lds
  s_add_u32 m0, s72, 20480
  s_nop 0
  buffer_load_dwordx4 v205, s[32:35], s75 offen lds
  s_add_u32 m0, s72, 24576
  s_nop 0
  buffer_load_dwordx4 v206, s[32:35], s75 offen lds
  s_add_u32 m0, s71, 0
  s_nop 0
  buffer_load_dwordx4 v207, s[52:55], s76 offen lds
  s_add_u32 s48, s48, 1
  s_cmp_eq_u32 s48, 10
  s_cselect_b32 s48, 0, s48
  s_waitcnt vmcnt(16)
  s_barrier
  s_lshl_b32 s74, s48, 7
  s_mul_i32 s75, s48, 81920
  s_mul_i32 s76, s48, s70
  s_add_u32 m0, s72, 32768
  s_nop 0
  buffer_load_dwordx4 v200, s[28:31], s74 offen lds
  s_add_u32 m0, s72, 36864
  s_nop 0
  buffer_load_dwordx4 v201, s[28:31], s74 offen lds
  s_add_u32 m0, s72, 40960
  s_nop 0
  buffer_load_dwordx4 v202, s[32:35], s75 offen lds
  s_add_u32 m0, s72, 45056
  s_nop 0
  buffer_load_dwordx4 v203, s[32:35], s75 offen lds
  s_add_u32 m0, s72, 49152
  s_nop 0
  buffer_load_dwordx4 v204, s[32:35], s75 offen lds
  s_add_u32 m0, s72, 53248
  s_nop 0
  buffer_load_dwordx4 v205, s[32:35], s75 offen lds
  s_add_u32 m0, s72, 57344
  s_nop 0
  buffer_load_dwordx4 v206, s[32:35], s75 offen lds
  s_add_u32 m0, s71, 32768
  s_nop 0
  buffer_load_dwordx4 v207, s[52:55], s76 offen lds
  s_add_u32 s48, s48, 1
  s_cmp_eq_u32 s48, 10
  s_cselect_b32 s48, 0, s48
  s_getpc_b64 s[80:81]
front_kernel_pc:
  s_add_u32 s80, s80, korder_table-front_kernel_pc
  s_addc_u32 s81, s81, 0
  v_lshrrev_b32 v10, 5, v2
  v_bfe_u32 v11, v2, 3, 2
  v_and_b32 v12, 7, v2
  v_lshlrev_b32 v12, 4, v12
  s_mul_i32 s46, s2, 6
  s_add_u32 s46, s46, s3
  s_mov_b32 s49, 0
  s_cmp_lt_u32 s46, 400
  s_cbranch_scc1 front_kernel_pp0_lo
  s_cmp_lt_u32 s46, 940
  s_cbranch_scc1 front_kernel_pp0_w3
  s_cmp_lt_u32 s46, 1480
  s_cbranch_scc1 front_kernel_pp0_w4
  s_mov_b32 s46, 0
  s_mov_b32 s49, 1
  s_branch front_kernel_pp0_w2
front_kernel_pp0_lo:
  s_cmp_ge_u32 s46, 200
  s_cbranch_scc1 front_kernel_pp0_wo
front_kernel_pp0_w2:
  s_mul_hi_u32 s47, s46, 429496730
  s_mul_i32 s50, s47, 10
  s_sub_u32 s50, s46, s50
  s_mov_b32 s84, s20
  s_mov_b32 s85, s21
  s_mov_b32 s86, 819200
  s_mov_b32 s51, 1280
  s_lshl_b32 s79, s47, 5
  s_add_u32 s79, s79, 0
  s_lshl_b32 s82, s50, 2
  s_mul_i32 s82, s82, 20
  s_add_u32 s82, s82, s47
  s_lshl_b32 s82, s82, 10
  s_add_u32 s82, s82, 1638400
  s_mov_b32 s83, 20480
  s_mov_b32 s56, 0
  s_branch front_kernel_pp0_go
front_kernel_pp0_wo:
  s_sub_u32 s46, s46, 200
  s_mul_hi_u32 s47, s46, 429496730
  s_mul_i32 s50, s47, 10
  s_sub_u32 s50, s46, s50
  s_mov_b32 s84, s22
  s_mov_b32 s85, s23
  s_mov_b32 s86, 819200
  s_mov_b32 s51, 1280
  s_lshl_b32 s79, s47, 5
  s_add_u32 s79, s79, 2368
  s_lshl_b32 s82, s50, 2
  s_mul_i32 s82, s82, 20
  s_add_u32 s82, s82, s47
  s_lshl_b32 s82, s82, 10
  s_add_u32 s82, s82, 2457600
  s_mov_b32 s83, 20480
  s_mov_b32 s56, 0
  s_branch front_kernel_pp0_go
front_kernel_pp0_w3:
  s_sub_u32 s46, s46, 400
  s_mul_hi_u32 s47, s46, 159072863
  s_mul_i32 s50, s47, 27
  s_sub_u32 s50, s46, s50
  s_mov_b32 s84, s24
  s_mov_b32 s85, s25
  s_mov_b32 s86, 2211840
  s_mov_b32 s51, 3456
  s_lshl_b32 s79, s47, 5
  s_add_u32 s79, s79, 0
  s_lshl_b32 s82, s50, 2
  s_mul_i32 s82, s82, 20
  s_add_u32 s82, s82, s47
  s_lshl_b32 s82, s82, 10
  s_add_u32 s82, s82, 3276800
  s_mov_b32 s83, 20480
  s_mov_b32 s56, 1
  s_branch front_kernel_pp0_go
front_kernel_pp0_w4:
  s_sub_u32 s46, s46, 940
  s_mul_hi_u32 s47, s46, 429496730
  s_mul_i32 s50, s47, 10
  s_sub_u32 s50, s46, s50
  s_mov_b32 s84, s26
  s_mov_b32 s85, s27
  s_mov_b32 s86, 2211840
  s_mov_b32 s51, 1280
  s_lshl_b32 s79, s47, 5
  s_add_u32 s79, s79, 640
  s_lshl_b32 s82, s50, 2
  s_mul_i32 s82, s82, 54
  s_add_u32 s82, s82, s47
  s_lshl_b32 s82, s82, 10
  s_add_u32 s82, s82, 5488640
  s_mov_b32 s83, 55296
  s_mov_b32 s56, 0
  s_branch front_kernel_pp0_go
front_kernel_pp0_go:
  s_mov_b32 s87, 0x20000
  s_cmp_eq_u32 s49, 0
  s_cselect_b32 s82, s82, 2130706432
  s_cselect_b32 s50, s50, 0x00ffff00
  s_mov_b32 s8, s82
  s_mov_b32 s9, s83
  s_mov_b32 s10, s47
  s_mov_b32 s11, s50
  s_add_u32 s90, s80, s79
  s_addc_u32 s91, s81, 0
  s_load_dwordx8 s[92:99], s[90:91], 0
  s_lshl_b32 s50, s50, 7
  s_waitcnt lgkmcnt(0)
  v_mul_lo_u32 v6, v10, s96
  v_add_u32 v6, v6, v11
  v_add_u32 v6, s92, v6
  v_mul_lo_u32 v6, v6, s51
  v_add_u32 v6, v6, v12
  s_lshl_b32 s46, s3, 12
  s_add_u32 m0, s46, 131072
  s_nop 0
  buffer_load_dwordx4 v6, s[84:87], s50 offen lds
  v_mul_lo_u32 v6, v10, s97
  v_add_u32 v6, v6, v11
  v_add_u32 v6, s93, v6
  v_mul_lo_u32 v6, v6, s51
  v_add_u32 v6, v6, v12
  s_lshl_b32 s46, s3, 12
  s_add_u32 m0, s46, 132096
  s_nop 0
  buffer_load_dwordx4 v6, s[84:87], s50 offen lds
  v_mul_lo_u32 v6, v10, s98
  v_add_u32 v6, v6, v11
  v_add_u32 v6, s94, v6
  v_mul_lo_u32 v6, v6, s51
  v_add_u32 v6, v6, v12
  s_lshl_b32 s46, s3, 12
  s_add_u32 m0, s46, 133120
  s_nop 0
  buffer_load_dwordx4 v6, s[84:87], s50 offen lds
  v_mul_lo_u32 v6, v10, s99
  v_add_u32 v6, v6, v11
  v_add_u32 v6, s95, v6
  v_mul_lo_u32 v6, v6, s51
  v_add_u32 v6, v6, v12
  s_lshl_b32 s46, s3, 12
  s_add_u32 m0, s46, 134144
  s_nop 0
  buffer_load_dwordx4 v6, s[84:87], s50 offen lds
  s_mul_i32 s46, s2, 6
  s_add_u32 s46, s46, s3
  s_mov_b32 s49, 0
  s_add_u32 s46, s46, 4
  s_cmp_lt_u32 s3, 2
  s_cselect_b32 s46, s46, 9999
  s_cmp_lt_u32 s46, 400
  s_cbranch_scc1 front_kernel_pp1_lo
  s_cmp_lt_u32 s46, 940
  s_cbranch_scc1 front_kernel_pp1_w3
  s_cmp_lt_u32 s46, 1480
  s_cbranch_scc1 front_kernel_pp1_w4
  s_mov_b32 s46, 0
  s_mov_b32 s49, 1
  s_branch front_kernel_pp1_w2
front_kernel_pp1_lo:
  s_cmp_ge_u32 s46, 200
  s_cbranch_scc1 front_kernel_pp1_wo
front_kernel_pp1_w2:
  s_mul_hi_u32 s47, s46, 429496730
  s_mul_i32 s50, s47, 10
  s_sub_u32 s50, s46, s50
  s_mov_b32 s84, s20
  s_mov_b32 s85, s21
  s_mov_b32 s86, 819200
  s_mov_b32 s51, 1280
  s_lshl_b32 s79, s47, 5
  s_add_u32 s79, s79, 0
  s_lshl_b32 s82, s50, 2
  s_mul_i32 s82, s82, 20
  s_add_u32 s82, s82, s47
  s_lshl_b32 s82, s82, 10
  s_add_u32 s82, s82, 1638400
  s_mov_b32 s83, 20480
  s_mov_b32 s57, 0
  s_branch front_kernel_pp1_go
front_kernel_pp1_wo:
  s_sub_u32 s46, s46, 200
  s_mul_hi_u32 s47, s46, 429496730
  s_mul_i32 s50, s47, 10
  s_sub_u32 s50, s46, s50
  s_mov_b32 s84, s22
  s_mov_b32 s85, s23
  s_mov_b32 s86, 819200
  s_mov_b32 s51, 1280
  s_lshl_b32 s79, s47, 5
  s_add_u32 s79, s79, 2368
  s_lshl_b32 s82, s50, 2
  s_mul_i32 s82, s82, 20
  s_add_u32 s82, s82, s47
  s_lshl_b32 s82, s82, 10
  s_add_u32 s82, s82, 2457600
  s_mov_b32 s83, 20480
  s_mov_b32 s57, 0
  s_branch front_kernel_pp1_go
front_kernel_pp1_w3:
  s_sub_u32 s46, s46, 400
  s_mul_hi_u32 s47, s46, 159072863
  s_mul_i32 s50, s47, 27
  s_sub_u32 s50, s46, s50
  s_mov_b32 s84, s24
  s_mov_b32 s85, s25
  s_mov_b32 s86, 2211840
  s_mov_b32 s51, 3456
  s_lshl_b32 s79, s47, 5
  s_add_u32 s79, s79, 0
  s_lshl_b32 s82, s50, 2
  s_mul_i32 s82, s82, 20
  s_add_u32 s82, s82, s47
  s_lshl_b32 s82, s82, 10
  s_add_u32 s82, s82, 3276800
  s_mov_b32 s83, 20480
  s_mov_b32 s57, 1
  s_branch front_kernel_pp1_go
front_kernel_pp1_w4:
  s_sub_u32 s46, s46, 940
  s_mul_hi_u32 s47, s46, 429496730
  s_mul_i32 s50, s47, 10
  s_sub_u32 s50, s46, s50
  s_mov_b32 s84, s26
  s_mov_b32 s85, s27
  s_mov_b32 s86, 2211840
  s_mov_b32 s51, 1280
  s_lshl_b32 s79, s47, 5
  s_add_u32 s79, s79, 640
  s_lshl_b32 s82, s50, 2
  s_mul_i32 s82, s82, 54
  s_add_u32 s82, s82, s47
  s_lshl_b32 s82, s82, 10
  s_add_u32 s82, s82, 5488640
  s_mov_b32 s83, 55296
  s_mov_b32 s57, 0
  s_branch front_kernel_pp1_go
front_kernel_pp1_go:
  s_mov_b32 s87, 0x20000
  s_cmp_eq_u32 s49, 0
  s_cselect_b32 s82, s82, 2130706432
  s_cselect_b32 s50, s50, 0x00ffff00
  s_mov_b32 s12, s82
  s_mov_b32 s13, s83
  s_mov_b32 s14, s47
  s_mov_b32 s15, s50
  s_add_u32 s90, s80, s79
  s_addc_u32 s91, s81, 0
  s_load_dwordx8 s[92:99], s[90:91], 0
  s_lshl_b32 s50, s50, 7
  s_waitcnt lgkmcnt(0)
  v_mul_lo_u32 v6, v10, s96
  v_add_u32 v6, v6, v11
  v_add_u32 v6, s92, v6
  v_mul_lo_u32 v6, v6, s51
  v_add_u32 v6, v6, v12
  s_lshl_b32 s46, s3, 12
  s_add_u32 m0, s46, 147456
  s_nop 0
  buffer_load_dwordx4 v6, s[84:87], s50 offen lds
  v_mul_lo_u32 v6, v10, s97
  v_add_u32 v6, v6, v11
  v_add_u32 v6, s93, v6
  v_mul_lo_u32 v6, v6, s51
  v_add_u32 v6, v6, v12
  s_lshl_b32 s46, s3, 12
  s_add_u32 m0, s46, 148480
  s_nop 0
  buffer_load_dwordx4 v6, s[84:87], s50 offen lds
  v_mul_lo_u32 v6, v10, s98
  v_add_u32 v6, v6, v11
  v_add_u32 v6, s94, v6
  v_mul_lo_u32 v6, v6, s51
  v_add_u32 v6, v6, v12
  s_lshl_b32 s46, s3, 12
  s_add_u32 m0, s46, 149504
  s_nop 0
  buffer_load_dwordx4 v6, s[84:87], s50 offen lds
  v_mul_lo_u32 v6, v10, s99
  v_add_u32 v6, v6, v11
  v_add_u32 v6, s95, v6
  v_mul_lo_u32 v6, v6, s51
  v_add_u32 v6, v6, v12
  s_lshl_b32 s46, s3, 12
  s_add_u32 m0, s46, 150528
  s_nop 0
  buffer_load_dwordx4 v6, s[84:87], s50 offen lds
  s_mov_b32 s96, s4
  s_mov_b32 s97, s5
  s_mov_b32 s98, 30584832
  s_mov_b32 s99, 0x20000
  s_waitcnt vmcnt(24)
  s_barrier
  s_waitcnt vmcnt(16)
  s_barrier
  s_waitcnt vmcnt(0)
  v_lshrrev_b32 v5, 4, v2
  v_lshlrev_b32 v5, 2, v5
  v_and_b32 v6, 15, v2
  v_lshrrev_b32 v7, 2, v6
  v_add_u32 v5, v5, v7
  v_lshlrev_b32 v5, 7, v5
  v_and_b32 v6, 3, v2
  v_lshlrev_b32 v6, 3, v6
  v_add_u32 v5, v5, v6
  s_lshl_b32 s46, s3, 12
  s_add_u32 s46, s46, 131072
  v_add_u32 v5, s46, v5
  ds_read_b64_tr_b16 v[100:101], v5 offset:0
  ds_read_b64_tr_b16 v[102:103], v5 offset:2048
  ds_read_b64_tr_b16 v[104:105], v5 offset:32
  ds_read_b64_tr_b16 v[106:107], v5 offset:2080
  ds_read_b64_tr_b16 v[108:109], v5 offset:64
  ds_read_b64_tr_b16 v[110:111], v5 offset:2112
  ds_read_b64_tr_b16 v[112:113], v5 offset:96
  ds_read_b64_tr_b16 v[114:115], v5 offset:2144
  s_waitcnt lgkmcnt(0)
  s_mov_b32 s46, s8
  buffer_store_dwordx4 v[100:103], v3, s[96:99], s46 offen sc1
  s_add_u32 s46, s46, s9
  buffer_store_dwordx4 v[104:107], v3, s[96:99], s46 offen sc1
  s_add_u32 s46, s46, s9
  buffer_store_dwordx4 v[108:111], v3, s[96:99], s46 offen sc1
  s_add_u32 s46, s46, s9
  buffer_store_dwordx4 v[112:115], v3, s[96:99], s46 offen sc1
  s_cmp_eq_u32 s56, 0
  s_cbranch_scc1 front_kernel_nocs2
  v_dot2_f32_bf16 v120, v100, v96, 0
  v_dot2_f32_bf16 v120, v101, v96, v120
  v_dot2_f32_bf16 v120, v102, v96, v120
  v_dot2_f32_bf16 v120, v103, v96, v120
  v_dot2_f32_bf16 v121, v104, v96, 0
  v_dot2_f32_bf16 v121, v105, v96, v121
  v_dot2_f32_bf16 v121, v106, v96, v121
  v_dot2_f32_bf16 v121, v107, v96, v121
  v_dot2_f32_bf16 v122, v108, v96, 0
  v_dot2_f32_bf16 v122, v109, v96, v122
  v_dot2_f32_bf16 v122, v110, v96, v122
  v_dot2_f32_bf16 v122, v111, v96, v122
  v_dot2_f32_bf16 v123, v112, v96, 0
  v_dot2_f32_bf16 v123, v113, v96, v123
  v_dot2_f32_bf16 v123, v114, v96, v123
  v_dot2_f32_bf16 v123, v115, v96, v123
  v_mov_b32 v124, v120
  s_nop 1
  v_permlane16_swap_b32 v120, v124
  v_add_f32 v120, v120, v124
  v_mov_b32 v124, v120
  s_nop 1
  v_permlane32_swap_b32 v120, v124
  v_add_f32 v120, v120, v124
  v_mov_b32 v124, v121
  s_nop 1
  v_permlane16_swap_b32 v121, v124
  v_add_f32 v121, v121, v124
  v_mov_b32 v124, v121
  s_nop 1
  v_permlane32_swap_b32 v121, v124
  v_add_f32 v121, v121, v124
  v_mov_b32 v124, v122
  s_nop 1
  v_permlane16_swap_b32 v122, v124
  v_add_f32 v122, v122, v124
  v_mov_b32 v124, v122
  s_nop 1
  v_permlane32_swap_b32 v122, v124
  v_add_f32 v122, v122, v124
  v_mov_b32 v124, v123
  s_nop 1
  v_permlane16_swap_b32 v123, v124
  v_add_f32 v123, v123, v124
  v_mov_b32 v124, v123
  s_nop 1
  v_permlane32_swap_b32 v123, v124
  v_add_f32 v123, v123, v124
  v_cmp_eq_u32 vcc, 1, v14
  s_nop 1
  v_cndmask_b32 v120, v120, v121, vcc
  v_cmp_eq_u32 vcc, 2, v14
  s_nop 1
  v_cndmask_b32 v120, v120, v122, vcc
  v_cmp_eq_u32 vcc, 3, v14
  s_nop 1
  v_cndmask_b32 v120, v120, v123, vcc
  s_mul_i32 s46, s10, 6912
  s_lshl_b32 s47, s11, 8
  s_add_u32 s46, s46, s47
  s_add_u32 s46, s46, 28348416
  v_lshlrev_b32 v6, 2, v2
  buffer_store_dword v120, v6, s[96:99], s46 offen
front_kernel_nocs2:
  s_barrier
  v_lshrrev_b32 v5, 4, v2
  v_lshlrev_b32 v5, 2, v5
  v_and_b32 v6, 15, v2
  v_lshrrev_b32 v7, 2, v6
  v_add_u32 v5, v5, v7
  v_lshlrev_b32 v5, 7, v5
  v_and_b32 v6, 3, v2
  v_lshlrev_b32 v6, 3, v6
  v_add_u32 v5, v5, v6
  s_lshl_b32 s46, s3, 12
  s_add_u32 s46, s46, 131072
  v_add_u32 v5, s46, v5
  s_cmp_ge_u32 s3, 2
  s_cbranch_scc1 front_kernel_ppdone
  v_add_u32 v5, 16384, v5
  ds_read_b64_tr_b16 v[100:101], v5 offset:0
  ds_read_b64_tr_b16 v[102:103], v5 offset:2048
  ds_read_b64_tr_b16 v[104:105], v5 offset:32
  ds_read_b64_tr_b16 v[106:107], v5 offset:2080
  ds_read_b64_tr_b16 v[108:109], v5 offset:64
  ds_read_b64_tr_b16 v[110:111], v5 offset:2112
  ds_read_b64_tr_b16 v[112:113], v5 offset:96
  ds_read_b64_tr_b16 v[114:115], v5 offset:2144
  s_waitcnt lgkmcnt(0)
  s_mov_b32 s46, s12
  buffer_store_dwordx4 v[100:103], v3, s[96:99], s46 offen sc1
  s_add_u32 s46, s46, s13
  buffer_store_dwordx4 v[104:107], v3, s[96:99], s46 offen sc1
  s_add_u32 s46, s46, s13
  buffer_store_dwordx4 v[108:111], v3, s[96:99], s46 offen sc1
  s_add_u32 s46, s46, s13
  buffer_store_dwordx4 v[112:115], v3, s[96:99], s46 offen sc1
  s_cmp_eq_u32 s57, 0
  s_cbranch_scc1 front_kernel_nocs3
  v_dot2_f32_bf16 v120, v100, v96, 0
  v_dot2_f32_bf16 v120, v101, v96, v120
  v_dot2_f32_bf16 v120, v102, v96, v120
  v_dot2_f32_bf16 v120, v103, v96, v120
  v_dot2_f32_bf16 v121, v104, v96, 0
  v_dot2_f32_bf16 v121, v105, v96, v121
  v_dot2_f32_bf16 v121, v106, v96, v121
  v_dot2_f32_bf16 v121, v107, v96, v121
  v_dot2_f32_bf16 v122, v108, v96, 0
  v_dot2_f32_bf16 v122, v109, v96, v122
  v_dot2_f32_bf16 v122, v110, v96, v122
  v_dot2_f32_bf16 v122, v111, v96, v122
  v_dot2_f32_bf16 v123, v112, v96, 0
  v_dot2_f32_bf16 v123, v113, v96, v123
  v_dot2_f32_bf16 v123, v114, v96, v123
  v_dot2_f32_bf16 v123, v115, v96, v123
  v_mov_b32 v124, v120
  s_nop 1
  v_permlane16_swap_b32 v120, v124
  v_add_f32 v120, v120, v124
  v_mov_b32 v124, v120
  s_nop 1
  v_permlane32_swap_b32 v120, v124
  v_add_f32 v120, v120, v124
  v_mov_b32 v124, v121
  s_nop 1
  v_permlane16_swap_b32 v121, v124
  v_add_f32 v121, v121, v124
  v_mov_b32 v124, v121
  s_nop 1
  v_permlane32_swap_b32 v121, v124
  v_add_f32 v121, v121, v124
  v_mov_b32 v124, v122
  s_nop 1
  v_permlane16_swap_b32 v122, v124
  v_add_f32 v122, v122, v124
  v_mov_b32 v124, v122
  s_nop 1
  v_permlane32_swap_b32 v122, v124
  v_add_f32 v122, v122, v124
  v_mov_b32 v124, v123
  s_nop 1
  v_permlane16_swap_b32 v123, v124
  v_add_f32 v123, v123, v124
  v_mov_b32 v124, v123
  s_nop 1
  v_permlane32_swap_b32 v123, v124
  v_add_f32 v123, v123, v124
  v_cmp_eq_u32 vcc, 1, v14
  s_nop 1
  v_cndmask_b32 v120, v120, v121, vcc
  v_cmp_eq_u32 vcc, 2, v14
  s_nop 1
  v_cndmask_b32 v120, v120, v122, vcc
  v_cmp_eq_u32 vcc, 3, v14
  s_nop 1
  v_cndmask_b32 v120, v120, v123, vcc
  s_mul_i32 s46, s14, 6912
  s_lshl_b32 s47, s15, 8
  s_add_u32 s46, s46, s47
  s_add_u32 s46, s46, 28348416
  v_lshlrev_b32 v6, 2, v2
  buffer_store_dword v120, v6, s[96:99], s46 offen
front_kernel_nocs3:
front_kernel_ppdone:
  s_cmp_lg_u32 s2, 0
  s_cbranch_scc1 front_kernel_nz4
  v_mov_b32 v100, 0
  v_mov_b32 v101, 0
  v_mov_b32 v102, 0
  v_mov_b32 v103, 0
  s_lshl_b32 s46, s3, 10
  s_add_u32 s46, s46, 28344320
  buffer_store_dwordx4 v[100:103], v3, s[96:99], s46 offen
  s_cmp_ge_u32 s3, 2
  s_cbranch_scc1 front_kernel_nz4
  s_lshl_b32 s46, s3, 6
  v_add_u32 v6, s46, v2
  v_mul_u32_u24 v7, 205, v6
  v_lshrrev_b32 v7, 12, v7
  v_mul_u32_u24 v8, 20, v7
  v_sub_u32 v8, v6, v8
  v_mov_b32 v9, v7
  v_cmp_lt_u32 vcc, 2, v7
  v_subrev_u32 v10, 1, v7
  s_nop 0
  v_cndmask_b32 v9, v9, v10, vcc
  v_cmp_eq_u32 vcc, 5, v7
  v_mov_b32 v10, 3
  s_nop 0
  v_cndmask_b32 v9, v9, v10, vcc
  v_mov_b32 v10, 0
  v_cmp_eq_u32 vcc, 1, v7
  v_mov_b32 v11, 2047
  s_nop 0
  v_cndmask_b32 v10, v10, v11, vcc
  v_cmp_eq_u32 vcc, 3, v7
  v_mov_b32 v11, 1
  s_nop 0
  v_cndmask_b32 v10, v10, v11, vcc
  v_cmp_eq_u32 vcc, 4, v7
  v_mov_b32 v11, 2046
  s_nop 0
  v_cndmask_b32 v10, v10, v11, vcc
  v_cmp_eq_u32 vcc, 5, v7
  v_mov_b32 v11, 2047
  s_nop 0
  v_cndmask_b32 v10, v10, v11, vcc
  v_lshrrev_b32 v11, 4, v10
  v_mul_u32_u24 v11, 20480, v11
  v_mul_u32_u24 v9, 5, v9
  v_lshrrev_b32 v12, 2, v8
  v_add_u32 v9, v9, v12
  v_lshlrev_b32 v9, 10, v9
  v_add_u32 v11, v11, v9
  v_and_b32 v12, 3, v8
  v_lshlrev_b32 v12, 4, v12
  v_and_b32 v9, 15, v10
  v_add_u32 v12, v12, v9
  v_lshlrev_b32 v12, 4, v12
  v_add_u32 v11, v11, v12
  v_cmp_gt_u32 vcc, 120, v6
  v_mov_b32 v12, 2130706432
  s_nop 0
  v_cndmask_b32 v11, v12, v11, vcc
  s_mov_b32 s46, 10403840
  buffer_store_dwordx4 v[100:103], v11, s[96:99], s46 offen
front_kernel_nz4:
  s_barrier
  s_endpgm
front_kernel_compute:
  s_cmp_lg_u32 s3, 0
  s_cbranch_scc1 front_kernel_tp5
  s_load_dwordx2 s[30:31], s[0:1], 88
  s_waitcnt lgkmcnt(0)
  v_mov_b32 v16, s4
  v_mov_b32 v17, s5
  v_writelane_b32 v16, s6, 0
  v_writelane_b32 v17, s7, 0
  s_add_u32 s46, s6, 2097152
  s_addc_u32 s47, s7, 0
  v_writelane_b32 v16, s46, 1
  v_writelane_b32 v17, s47, 1
  v_writelane_b32 v16, s8, 2
  v_writelane_b32 v17, s9, 2
  v_writelane_b32 v16, s10, 3
  v_writelane_b32 v17, s11, 3
  v_writelane_b32 v16, s12, 4
  v_writelane_b32 v17, s13, 4
  v_writelane_b32 v16, s14, 5
  v_writelane_b32 v17, s15, 5
  v_writelane_b32 v16, s18, 6
  v_writelane_b32 v17, s19, 6
  v_writelane_b32 v16, s20, 7
  v_writelane_b32 v17, s21, 7
  v_writelane_b32 v16, s22, 8
  v_writelane_b32 v17, s23, 8
  v_writelane_b32 v16, s24, 9
  v_writelane_b32 v17, s25, 9
  s_add_u32 s46, s24, 2097152
  s_addc_u32 s47, s25, 0
  v_writelane_b32 v16, s46, 10
  v_writelane_b32 v17, s47, 10
  v_writelane_b32 v16, s26, 11
  v_writelane_b32 v17, s27, 11
  s_add_u32 s46, s26, 2097152
  s_addc_u32 s47, s27, 0
  v_writelane_b32 v16, s46, 12
  v_writelane_b32 v17, s47, 12
  v_writelane_b32 v16, s30, 13
  v_writelane_b32 v17, s31, 13
  s_add_u32 s46, s30, 2097152
  s_addc_u32 s47, s31, 0
  v_writelane_b32 v16, s46, 14
  v_writelane_b32 v17, s47, 14
  v_writelane_b32 v16, s4, 15
  v_writelane_b32 v17, s5, 15
  s_add_u32 s46, s4, 2097152
  s_addc_u32 s47, s5, 0
  v_writelane_b32 v16, s46, 16
  v_writelane_b32 v17, s47, 16
  s_add_u32 s46, s4, 4194304
  s_addc_u32 s47, s5, 0
  v_writelane_b32 v16, s46, 17
  v_writelane_b32 v17, s47, 17
  s_add_u32 s46, s4, 6291456
  s_addc_u32 s47, s5, 0
  v_writelane_b32 v16, s46, 18
  v_writelane_b32 v17, s47, 18
  s_add_u32 s46, s4, 8388608
  s_addc_u32 s47, s5, 0
  v_writelane_b32 v16, s46, 19
  v_writelane_b32 v17, s47, 19
  s_add_u32 s46, s4, 10485760
  s_addc_u32 s47, s5, 0
  v_writelane_b32 v16, s46, 20
  v_writelane_b32 v17, s47, 20
  s_add_u32 s46, s4, 12582912
  s_addc_u32 s47, s5, 0
  v_writelane_b32 v16, s46, 21
  v_writelane_b32 v17, s47, 21
  s_add_u32 s46, s4, 14680064
  s_addc_u32 s47, s5, 0
  v_writelane_b32 v16, s46, 22
  v_writelane_b32 v17, s47, 22
  s_add_u32 s46, s4, 16777216
  s_addc_u32 s47, s5, 0
  v_writelane_b32 v16, s46, 23
  v_writelane_b32 v17, s47, 23
  s_add_u32 s46, s4, 18874368
  s_addc_u32 s47, s5, 0
  v_writelane_b32 v16, s46, 24
  v_writelane_b32 v17, s47, 24
  s_add_u32 s46, s4, 20971520
  s_addc_u32 s47, s5, 0
  v_writelane_b32 v16, s46, 25
  v_writelane_b32 v17, s47, 25
  s_add_u32 s46, s4, 23068672
  s_addc_u32 s47, s5, 0
  v_writelane_b32 v16, s46, 26
  v_writelane_b32 v17, s47, 26
  s_add_u32 s46, s4, 25165824
  s_addc_u32 s47, s5, 0
  v_writelane_b32 v16, s46, 27
  v_writelane_b32 v17, s47, 27
  s_add_u32 s46, s4, 27262976
  s_addc_u32 s47, s5, 0
  v_writelane_b32 v16, s46, 28
  v_writelane_b32 v17, s47, 28
  s_add_u32 s46, s4, 29360128
  s_addc_u32 s47, s5, 0
  v_writelane_b32 v16, s46, 29
  v_writelane_b32 v17, s47, 29
  global_load_dword v222, v[16:17], off
front_kernel_tp5:
  s_lshr_b32 s44, s3, 1
  s_and_b32 s45, s3, 1
  v_and_b32 v13, 15, v2
  v_lshrrev_b32 v14, 4, v2
  s_and_b32 s46, s43, 1
  s_xor_b32 s46, s46, 0
  s_lshl_b32 s47, s44, 1
  s_add_u32 s46, s46, s47
  s_lshl_b32 s46, s46, 4
  v_add_u32 v6, s46, v13
  v_bfe_u32 v7, v6, 1, 3
  v_xor_b32 v7, v7, v14
  v_lshlrev_b32 v7, 4, v7
  v_lshlrev_b32 v6, 7, v6
  v_add_u32 v184, v6, v7
  v_xor_b32 v185, 64, v184
  s_and_b32 s46, s43, 1
  s_xor_b32 s46, s46, 1
  s_lshl_b32 s47, s44, 1
  s_add_u32 s46, s46, s47
  s_lshl_b32 s46, s46, 4
  v_add_u32 v6, s46, v13
  v_bfe_u32 v7, v6, 1, 3
  v_xor_b32 v7, v7, v14
  v_lshlrev_b32 v7, 4, v7
  v_lshlrev_b32 v6, 7, v6
  v_add_u32 v186, v6, v7
  v_xor_b32 v187, 64, v186
  v_lshrrev_b32 v6, 1, v14
  v_lshlrev_b32 v6, 4, v6
  v_and_b32 v9, 1, v14
  v_lshlrev_b32 v7, 2, v9
  v_add_u32 v6, v6, v7
  v_lshrrev_b32 v7, 2, v13
  v_add_u32 v6, v6, v7
  v_mul_u32_u24 v6, 320, v6
  v_and_b32 v7, 3, v2
  v_lshlrev_b32 v7, 3, v7
  v_add_u32 v6, v6, v7
  v_lshlrev_b32 v8, 5, v9
  s_mul_i32 s46, s45, 160
  s_add_u32 s46, s46, 8192
  v_add_u32 v6, s46, v6
  v_add_u32 v10, v6, v8
  v_sub_u32 v11, v6, v8
  s_cmp_eq_u32 s45, 0
  s_cselect_b64 vcc, -1, 0
  v_cndmask_b32 v188, v11, v10, vcc
  v_cndmask_b32 v191, v10, v11, vcc
  v_lshlrev_b32 v6, 3, v14
  v_lshrrev_b32 v8, 2, v13
  v_add_u32 v6, v6, v8
  v_mul_u32_u24 v6, 40, v6
  v_add_u32 v6, v6, v7
  v_add_u32 v189, 28672, v6
  v_lshlrev_b32 v6, 4, v14
  v_add_u32 v190, 31744, v6
  v_mov_b32 v96, 0x3f803f80
  v_mov_b32 v97, 0x3f803f80
  v_mov_b32 v98, 0x3f803f80
  v_mov_b32 v99, 0x3f803f80
  v_mov_b32 v16, 0
  v_mov_b32 v17, 0
  v_mov_b32 v18, 0
  v_mov_b32 v19, 0
  v_mov_b32 v20, 0
  v_mov_b32 v21, 0
  v_mov_b32 v22, 0
  v_mov_b32 v23, 0
  v_mov_b32 v24, 0
  v_mov_b32 v25, 0
  v_mov_b32 v26, 0
  v_mov_b32 v27, 0
  v_mov_b32 v28, 0
  v_mov_b32 v29, 0
  v_mov_b32 v30, 0
  v_mov_b32 v31, 0
  v_mov_b32 v32, 0
  v_mov_b32 v33, 0
  v_mov_b32 v34, 0
  v_mov_b32 v35, 0
  v_mov_b32 v36, 0
  v_mov_b32 v37, 0
  v_mov_b32 v38, 0
  v_mov_b32 v39, 0
  v_mov_b32 v40, 0
  v_mov_b32 v41, 0
  v_mov_b32 v42, 0
  v_mov_b32 v43, 0
  v_mov_b32 v44, 0
  v_mov_b32 v45, 0
  v_mov_b32 v46, 0
  v_mov_b32 v47, 0
  v_mov_b32 v48, 0
  v_mov_b32 v49, 0
  v_mov_b32 v50, 0
  v_mov_b32 v51, 0
  v_mov_b32 v52, 0
  v_mov_b32 v53, 0
  v_mov_b32 v54, 0
  v_mov_b32 v55, 0
  v_mov_b32 v56, 0
  v_mov_b32 v57, 0
  v_mov_b32 v58, 0
  v_mov_b32 v59, 0
  v_mov_b32 v60, 0
  v_mov_b32 v61, 0
  v_mov_b32 v62, 0
  v_mov_b32 v63, 0
  v_mov_b32 v64, 0
  v_mov_b32 v65, 0
  v_mov_b32 v66, 0
  v_mov_b32 v67, 0
  v_mov_b32 v68, 0
  v_mov_b32 v69, 0
  v_mov_b32 v70, 0
  v_mov_b32 v71, 0
  v_mov_b32 v72, 0
  v_mov_b32 v73, 0
  v_mov_b32 v74, 0
  v_mov_b32 v75, 0
  v_mov_b32 v76, 0
  v_mov_b32 v77, 0
  v_mov_b32 v78, 0
  v_mov_b32 v79, 0
  v_mov_b32 v80, 0
  v_mov_b32 v81, 0
  v_mov_b32 v82, 0
  v_mov_b32 v83, 0
  v_mov_b32 v84, 0
  v_mov_b32 v85, 0
  v_mov_b32 v86, 0
  v_mov_b32 v87, 0
  v_mov_b32 v88, 0
  v_mov_b32 v89, 0
  v_mov_b32 v90, 0
  v_mov_b32 v91, 0
  v_mov_b32 v92, 0
  v_mov_b32 v93, 0
  v_mov_b32 v94, 0
  v_mov_b32 v95, 0
  s_lshr_b32 s46, s43, 1
  s_cmp_eq_u32 s46, s44
  s_cselect_b32 s79, 1, 0
  s_cmp_eq_u32 s45, 0
  s_cselect_b32 s79, s79, 0
  s_mul_i32 s47, s43, 10
  s_mul_i32 s46, s45, 5
  s_add_u32 s47, s47, s46
  s_add_u32 s46, s47, 0
  s_lshl_b32 s46, s46, 2
  v_add_u32 v9, s46, v14
  v_mul_u32_u24 v10, 205, v9
  v_lshrrev_b32 v10, 10, v10
  v_mul_u32_u24 v11, 5, v10
  v_sub_u32 v11, v9, v11
  v_mul_u32_u24 v12, 81920, v10
  v_lshrrev_b32 v9, 1, v11
  v_lshlrev_b32 v9, 9, v9
  v_and_b32 v10, 1, v11
  v_lshl_or_b32 v9, v10, 3, v9
  v_add_u32 v212, v12, v9
  v_cmp_eq_u32 vcc, 4, v11
  v_mov_b32 v9, 4
  v_mov_b32 v10, 3
  v_cndmask_b32 v217, v9, v10, vcc
  s_add_u32 s46, s47, 1
  s_lshl_b32 s46, s46, 2
  v_add_u32 v9, s46, v14
  v_mul_u32_u24 v10, 205, v9
  v_lshrrev_b32 v10, 10, v10
  v_mul_u32_u24 v11, 5, v10
  v_sub_u32 v11, v9, v11
  v_mul_u32_u24 v12, 81920, v10
  v_lshrrev_b32 v9, 1, v11
  v_lshlrev_b32 v9, 9, v9
  v_and_b32 v10, 1, v11
  v_lshl_or_b32 v9, v10, 3, v9
  v_add_u32 v213, v12, v9
  v_cmp_eq_u32 vcc, 4, v11
  v_mov_b32 v9, 4
  v_mov_b32 v10, 3
  v_cndmask_b32 v218, v9, v10, vcc
  s_add_u32 s46, s47, 2
  s_lshl_b32 s46, s46, 2
  v_add_u32 v9, s46, v14
  v_mul_u32_u24 v10, 205, v9
  v_lshrrev_b32 v10, 10, v10
  v_mul_u32_u24 v11, 5, v10
  v_sub_u32 v11, v9, v11
  v_mul_u32_u24 v12, 81920, v10
  v_lshrrev_b32 v9, 1, v11
  v_lshlrev_b32 v9, 9, v9
  v_and_b32 v10, 1, v11
  v_lshl_or_b32 v9, v10, 3, v9
  v_add_u32 v214, v12, v9
  v_cmp_eq_u32 vcc, 4, v11
  v_mov_b32 v9, 4
  v_mov_b32 v10, 3
  v_cndmask_b32 v219, v9, v10, vcc
  s_add_u32 s46, s47, 3
  s_lshl_b32 s46, s46, 2
  v_add_u32 v9, s46, v14
  v_mul_u32_u24 v10, 205, v9
  v_lshrrev_b32 v10, 10, v10
  v_mul_u32_u24 v11, 5, v10
  v_sub_u32 v11, v9, v11
  v_mul_u32_u24 v12, 81920, v10
  v_lshrrev_b32 v9, 1, v11
  v_lshlrev_b32 v9, 9, v9
  v_and_b32 v10, 1, v11
  v_lshl_or_b32 v9, v10, 3, v9
  v_add_u32 v215, v12, v9
  v_cmp_eq_u32 vcc, 4, v11
  v_mov_b32 v9, 4
  v_mov_b32 v10, 3
  v_cndmask_b32 v220, v9, v10, vcc
  s_add_u32 s46, s47, 4
  s_lshl_b32 s46, s46, 2
  v_add_u32 v9, s46, v14
  v_mul_u32_u24 v10, 205, v9
  v_lshrrev_b32 v10, 10, v10
  v_mul_u32_u24 v11, 5, v10
  v_sub_u32 v11, v9, v11
  v_mul_u32_u24 v12, 81920, v10
  v_lshrrev_b32 v9, 1, v11
  v_lshlrev_b32 v9, 9, v9
  v_and_b32 v10, 1, v11
  v_lshl_or_b32 v9, v10, 3, v9
  v_add_u32 v216, v12, v9
  v_cmp_eq_u32 vcc, 4, v11
  v_mov_b32 v9, 4
  v_mov_b32 v10, 3
  v_cndmask_b32 v221, v9, v10, vcc
  s_waitcnt lgkmcnt(0)
  s_mov_b32 s96, s4
  s_mov_b32 s97, s5
  s_mov_b32 s98, 30584832
  s_mov_b32 s99, 0x20000
  s_mov_b32 s78, 0
  s_mov_b32 s83, 0
  s_barrier
  s_cmp_lg_u32 s42, 0
  s_cbranch_scc1 front_kernel_H
  v_add_u32 v192, s78, v184
  v_add_u32 v193, s78, v185
  v_add_u32 v194, s78, v186
  v_add_u32 v195, s78, v187
  v_add_u32 v196, s78, v188
  v_add_u32 v199, s78, v191
  v_add_u32 v197, s78, v189
  v_add_u32 v198, s78, v190
  ds_read_b128 v[100:103], v192
  ds_read_b128 v[104:107], v194
  ds_read_b64_tr_b16 v[108:109], v196 offset:0
  ds_read_b64_tr_b16 v[110:111], v196 offset:2560
  ds_read_b64_tr_b16 v[112:113], v199 offset:32
  ds_read_b64_tr_b16 v[114:115], v199 offset:2592
  ds_read_b64_tr_b16 v[116:117], v196 offset:64
  ds_read_b64_tr_b16 v[118:119], v196 offset:2624
  ds_read_b64_tr_b16 v[120:121], v199 offset:96
  ds_read_b64_tr_b16 v[122:123], v199 offset:2656
  ds_read_b64_tr_b16 v[124:125], v196 offset:128
  ds_read_b64_tr_b16 v[126:127], v196 offset:2688
  ds_read_b128 v[136:139], v198 offset:0
  s_waitcnt lgkmcnt(8)
  s_cmp_eq_u32 s79, 0
  s_cbranch_scc1 front_kernel_kr6
  ds_read_b64_tr_b16 v[128:129], v197 offset:0
  ds_read_b64_tr_b16 v[130:131], v197 offset:160
  ds_read_b64_tr_b16 v[132:133], v197 offset:32
  ds_read_b64_tr_b16 v[134:135], v197 offset:192
front_kernel_kr6:
front_kernel_loop0:
  s_waitcnt lgkmcnt(0)
  s_cmp_eq_u32 s79, 0
  s_cbranch_scc1 front_kernel_kr7
  ds_read_b64_tr_b16 v[168:169], v197 offset:1280
  ds_read_b64_tr_b16 v[170:171], v197 offset:1440
  ds_read_b64_tr_b16 v[172:173], v197 offset:1312
  ds_read_b64_tr_b16 v[174:175], v197 offset:1472
front_kernel_kr7:
  v_mfma_f32_16x16x32_bf16 v[16:19], v[108:111], v[100:103], v[16:19]
  ds_read_b128 v[140:143], v193
  ds_read_b128 v[144:147], v195
  v_mfma_f32_16x16x32_bf16 v[36:39], v[108:111], v[104:107], v[36:39]
  ds_read_b64_tr_b16 v[148:149], v196 offset:10240
  ds_read_b64_tr_b16 v[150:151], v196 offset:12800
  v_mfma_f32_16x16x32_bf16 v[20:23], v[112:115], v[100:103], v[20:23]
  ds_read_b64_tr_b16 v[152:153], v199 offset:10272
  ds_read_b64_tr_b16 v[154:155], v199 offset:12832
  v_mfma_f32_16x16x32_bf16 v[40:43], v[112:115], v[104:107], v[40:43]
  ds_read_b64_tr_b16 v[156:157], v196 offset:10304
  ds_read_b64_tr_b16 v[158:159], v196 offset:12864
  v_mfma_f32_16x16x32_bf16 v[24:27], v[116:119], v[100:103], v[24:27]
  ds_read_b64_tr_b16 v[160:161], v199 offset:10336
  ds_read_b64_tr_b16 v[162:163], v199 offset:12896
  v_mfma_f32_16x16x32_bf16 v[44:47], v[116:119], v[104:107], v[44:47]
  ds_read_b64_tr_b16 v[164:165], v196 offset:10368
  ds_read_b64_tr_b16 v[166:167], v196 offset:12928
  v_mfma_f32_16x16x32_bf16 v[28:31], v[120:123], v[100:103], v[28:31]
  ds_read_b128 v[176:179], v198 offset:64
  v_dot2_f32_bf16 v94, v100, v136, v94
  v_mfma_f32_16x16x32_bf16 v[48:51], v[120:123], v[104:107], v[48:51]
  v_dot2_f32_bf16 v94, v101, v137, v94
  v_mfma_f32_16x16x32_bf16 v[32:35], v[124:127], v[100:103], v[32:35]
  v_dot2_f32_bf16 v94, v102, v138, v94
  v_mfma_f32_16x16x32_bf16 v[52:55], v[124:127], v[104:107], v[52:55]
  v_dot2_f32_bf16 v94, v103, v139, v94
  v_dot2_f32_bf16 v95, v104, v136, v95
  v_dot2_f32_bf16 v95, v105, v137, v95
  v_dot2_f32_bf16 v95, v106, v138, v95
  v_dot2_f32_bf16 v95, v107, v139, v95
  s_cmp_eq_u32 s79, 0
  s_cbranch_scc1 front_kernel_kv8
  v_mfma_f32_16x16x32_bf16 v[84:87], v[128:131], v[100:103], v[84:87]
  v_mfma_f32_16x16x32_bf16 v[88:91], v[132:135], v[100:103], v[88:91]
front_kernel_kv8:
  s_add_u32 s78, s78, 32768
  s_cmp_eq_u32 s78, 131072
  s_cselect_b32 s78, 0, s78
  s_waitcnt lgkmcnt(0)
  s_barrier
  v_add_u32 v192, s78, v184
  v_add_u32 v193, s78, v185
  v_add_u32 v194, s78, v186
  v_add_u32 v195, s78, v187
  v_add_u32 v196, s78, v188
  v_add_u32 v199, s78, v191
  v_add_u32 v197, s78, v189
  v_add_u32 v198, s78, v190
  s_cmp_eq_u32 s79, 0
  s_cbranch_scc1 front_kernel_kr9
  ds_read_b64_tr_b16 v[128:129], v197 offset:0
  ds_read_b64_tr_b16 v[130:131], v197 offset:160
  ds_read_b64_tr_b16 v[132:133], v197 offset:32
  ds_read_b64_tr_b16 v[134:135], v197 offset:192
front_kernel_kr9:
  v_mfma_f32_16x16x32_bf16 v[16:19], v[148:151], v[140:143], v[16:19]
  ds_read_b128 v[100:103], v192
  ds_read_b128 v[104:107], v194
  v_mfma_f32_16x16x32_bf16 v[36:39], v[148:151], v[144:147], v[36:39]
  ds_read_b64_tr_b16 v[108:109], v196 offset:0
  ds_read_b64_tr_b16 v[110:111], v196 offset:2560
  v_mfma_f32_16x16x32_bf16 v[20:23], v[152:155], v[140:143], v[20:23]
  ds_read_b64_tr_b16 v[112:113], v199 offset:32
  ds_read_b64_tr_b16 v[114:115], v199 offset:2592
  v_mfma_f32_16x16x32_bf16 v[40:43], v[152:155], v[144:147], v[40:43]
  ds_read_b64_tr_b16 v[116:117], v196 offset:64
  ds_read_b64_tr_b16 v[118:119], v196 offset:2624
  v_mfma_f32_16x16x32_bf16 v[24:27], v[156:159], v[140:143], v[24:27]
  ds_read_b64_tr_b16 v[120:121], v199 offset:96
  ds_read_b64_tr_b16 v[122:123], v199 offset:2656
  v_mfma_f32_16x16x32_bf16 v[44:47], v[156:159], v[144:147], v[44:47]
  ds_read_b64_tr_b16 v[124:125], v196 offset:128
  ds_read_b64_tr_b16 v[126:127], v196 offset:2688
  v_mfma_f32_16x16x32_bf16 v[28:31], v[160:163], v[140:143], v[28:31]
  ds_read_b128 v[136:139], v198 offset:0
  v_dot2_f32_bf16 v94, v140, v176, v94
  v_mfma_f32_16x16x32_bf16 v[48:51], v[160:163], v[144:147], v[48:51]
  v_dot2_f32_bf16 v94, v141, v177, v94
  v_mfma_f32_16x16x32_bf16 v[32:35], v[164:167], v[140:143], v[32:35]
  v_dot2_f32_bf16 v94, v142, v178, v94
  v_mfma_f32_16x16x32_bf16 v[52:55], v[164:167], v[144:147], v[52:55]
  v_dot2_f32_bf16 v94, v143, v179, v94
  v_dot2_f32_bf16 v95, v144, v176, v95
  v_dot2_f32_bf16 v95, v145, v177, v95
  v_dot2_f32_bf16 v95, v146, v178, v95
  v_dot2_f32_bf16 v95, v147, v179, v95
  s_cmp_eq_u32 s79, 0
  s_cbranch_scc1 front_kernel_kv10
  v_mfma_f32_16x16x32_bf16 v[84:87], v[168:171], v[140:143], v[84:87]
  v_mfma_f32_16x16x32_bf16 v[88:91], v[172:175], v[140:143], v[88:91]
front_kernel_kv10:
  s_add_u32 s83, s83, 1
  s_cmp_lt_u32 s83, 10
  s_cbranch_scc1 front_kernel_loop0
  s_waitcnt lgkmcnt(0)
  s_nop 7
  s_and_b32 s46, s43, 1
  s_xor_b32 s46, s46, 0
  s_lshl_b32 s47, s44, 1
  s_add_u32 s46, s46, s47
  s_lshl_b32 s47, s40, 2
  s_add_u32 s84, s46, s47
  s_lshl_b32 s47, s84, 4
  v_add_u32 v5, s47, v13
  s_and_b32 s46, s43, 1
  s_xor_b32 s46, s46, 1
  s_lshl_b32 s47, s44, 1
  s_add_u32 s46, s46, s47
  s_lshl_b32 s47, s40, 2
  s_add_u32 s85, s46, s47
  s_lshl_b32 s47, s85, 4
  v_add_u32 v6, s47, v13
  s_mov_b32 s70, 1051011932
  s_mov_b32 s71, 25346048
  v_lshrrev_b32 v7, 5, v5
  v_mul_u32_u24 v7, 1280, v7
  v_and_b32 v8, 31, v5
  v_mul_f32 v16, s70, v16
  v_mul_f32 v17, s70, v17
  v_mul_f32 v18, s70, v18
  v_mul_f32 v19, s70, v19
  v_mul_f32 v20, s70, v20
  v_mul_f32 v21, s70, v21
  v_mul_f32 v22, s70, v22
  v_mul_f32 v23, s70, v23
  v_mul_f32 v24, s70, v24
  v_mul_f32 v25, s70, v25
  v_mul_f32 v26, s70, v26
  v_mul_f32 v27, s70, v27
  v_mul_f32 v28, s70, v28
  v_mul_f32 v29, s70, v29
  v_mul_f32 v30, s70, v30
  v_mul_f32 v31, s70, v31
  v_mul_f32 v32, s70, v32
  v_mul_f32 v33, s70, v33
  v_mul_f32 v34, s70, v34
  v_mul_f32 v35, s70, v35
  v_cvt_pk_bf16_f32 v100, v16, v17
  v_cvt_pk_bf16_f32 v101, v18, v19
  v_lshlrev_b32 v9, v217, v8
  v_add3_u32 v130, v9, v7, v212
  v_cvt_pk_bf16_f32 v102, v20, v21
  v_cvt_pk_bf16_f32 v103, v22, v23
  v_lshlrev_b32 v9, v218, v8
  v_add3_u32 v131, v9, v7, v213
  v_cvt_pk_bf16_f32 v104, v24, v25
  v_cvt_pk_bf16_f32 v105, v26, v27
  v_lshlrev_b32 v9, v219, v8
  v_add3_u32 v132, v9, v7, v214
  v_cvt_pk_bf16_f32 v106, v28, v29
  v_cvt_pk_bf16_f32 v107, v30, v31
  v_lshlrev_b32 v9, v220, v8
  v_add3_u32 v133, v9, v7, v215
  v_cvt_pk_bf16_f32 v108, v32, v33
  v_cvt_pk_bf16_f32 v109, v34, v35
  v_lshlrev_b32 v9, v221, v8
  v_add3_u32 v134, v9, v7, v216
  buffer_store_dwordx2 v[100:101], v130, s[96:99], s71 offen
  buffer_store_dwordx2 v[102:103], v131, s[96:99], s71 offen
  buffer_store_dwordx2 v[104:105], v132, s[96:99], s71 offen
  buffer_store_dwordx2 v[106:107], v133, s[96:99], s71 offen
  buffer_store_dwordx2 v[108:109], v134, s[96:99], s71 offen
  v_lshrrev_b32 v7, 5, v6
  v_mul_u32_u24 v7, 1280, v7
  v_and_b32 v8, 31, v6
  v_mul_f32 v36, s70, v36
  v_mul_f32 v37, s70, v37
  v_mul_f32 v38, s70, v38
  v_mul_f32 v39, s70, v39
  v_mul_f32 v40, s70, v40
  v_mul_f32 v41, s70, v41
  v_mul_f32 v42, s70, v42
  v_mul_f32 v43, s70, v43
  v_mul_f32 v44, s70, v44
  v_mul_f32 v45, s70, v45
  v_mul_f32 v46, s70, v46
  v_mul_f32 v47, s70, v47
  v_mul_f32 v48, s70, v48
  v_mul_f32 v49, s70, v49
  v_mul_f32 v50, s70, v50
  v_mul_f32 v51, s70, v51
  v_mul_f32 v52, s70, v52
  v_mul_f32 v53, s70, v53
  v_mul_f32 v54, s70, v54
  v_mul_f32 v55, s70, v55
  v_cvt_pk_bf16_f32 v110, v36, v37
  v_cvt_pk_bf16_f32 v111, v38, v39
  v_lshlrev_b32 v9, v217, v8
  v_add3_u32 v135, v9, v7, v212
  v_cvt_pk_bf16_f32 v112, v40, v41
  v_cvt_pk_bf16_f32 v113, v42, v43
  v_lshlrev_b32 v9, v218, v8
  v_add3_u32 v136, v9, v7, v213
  v_cvt_pk_bf16_f32 v114, v44, v45
  v_cvt_pk_bf16_f32 v115, v46, v47
  v_lshlrev_b32 v9, v219, v8
  v_add3_u32 v137, v9, v7, v214
  v_cvt_pk_bf16_f32 v116, v48, v49
  v_cvt_pk_bf16_f32 v117, v50, v51
  v_lshlrev_b32 v9, v220, v8
  v_add3_u32 v138, v9, v7, v215
  v_cvt_pk_bf16_f32 v118, v52, v53
  v_cvt_pk_bf16_f32 v119, v54, v55
  v_lshlrev_b32 v9, v221, v8
  v_add3_u32 v139, v9, v7, v216
  buffer_store_dwordx2 v[110:111], v135, s[96:99], s71 offen
  buffer_store_dwordx2 v[112:113], v136, s[96:99], s71 offen
  buffer_store_dwordx2 v[114:115], v137, s[96:99], s71 offen
  buffer_store_dwordx2 v[116:117], v138, s[96:99], s71 offen
  buffer_store_dwordx2 v[118:119], v139, s[96:99], s71 offen
  s_or_b32 s46, s43, s45
  s_cmp_lg_u32 s46, 0
  s_cbranch_scc1 front_kernel_ng11
  v_mov_b32 v7, v94
  s_nop 1
  v_permlane16_swap_b32 v94, v7
  v_add_f32 v94, v94, v7
  v_mov_b32 v7, v94
  s_nop 1
  v_permlane32_swap_b32 v94, v7
  v_add_f32 v94, v94, v7
  v_mul_f32 v94, 3216550459, v94
  v_exp_f32 v94, v94
  s_nop 0
  v_add_f32 v94, 1.0, v94
  v_rcp_f32 v94, v94
  v_lshlrev_b32 v7, 2, v5
  s_mov_b32 s46, 28180480
  buffer_store_dword v94, v7, s[96:99], s46 offen
  v_mov_b32 v7, v95
  s_nop 1
  v_permlane16_swap_b32 v95, v7
  v_add_f32 v95, v95, v7
  v_mov_b32 v7, v95
  s_nop 1
  v_permlane32_swap_b32 v95, v7
  v_add_f32 v95, v95, v7
  v_mul_f32 v95, 3216550459, v95
  v_exp_f32 v95, v95
  s_nop 0
  v_add_f32 v95, 1.0, v95
  v_rcp_f32 v95, v95
  v_lshlrev_b32 v7, 2, v6
  s_mov_b32 s46, 28180480
  buffer_store_dword v95, v7, s[96:99], s46 offen
front_kernel_ng11:
  s_cmp_eq_u32 s79, 0
  s_cbranch_scc1 front_kernel_nk12
  s_lshr_b32 s71, s84, 1
  s_mul_i32 s71, s71, 3072
  s_add_u32 s71, s71, 27967488
  v_and_b32 v8, 31, v5
  v_cvt_pk_bf16_f32 v150, v84, v85
  v_cvt_pk_bf16_f32 v151, v86, v87
  v_cvt_pk_bf16_f32 v152, v88, v89
  v_cvt_pk_bf16_f32 v153, v90, v91
  v_lshrrev_b32 v9, 1, v14
  v_lshlrev_b32 v9, 5, v9
  v_add_u32 v9, v9, v8
  v_lshlrev_b32 v9, 4, v9
  v_and_b32 v10, 1, v14
  v_lshlrev_b32 v10, 3, v10
  v_add_u32 v9, v9, v10
  buffer_store_dwordx2 v[150:151], v9, s[96:99], s71 offen
  v_lshrrev_b32 v9, 3, v8
  v_lshlrev_b32 v12, 9, v9
  v_add_u32 v12, 1344, v12
  v_and_b32 v9, 7, v8
  v_lshlrev_b32 v9, 3, v9
  v_add_u32 v12, v12, v9
  v_cmp_eq_u32 vcc, 0, v14
  v_mov_b32 v9, 2130706432
  s_nop 0
  v_cndmask_b32 v12, v9, v12, vcc
  buffer_store_dwordx2 v[152:153], v12, s[96:99], s71 offen
  v_dot2_f32_bf16 v11, v150, v150, 0
  v_dot2_f32_bf16 v11, v151, v151, v11
  v_dot2_f32_bf16 v10, v152, v152, 0
  v_dot2_f32_bf16 v10, v153, v153, v10
  s_nop 2
  v_cndmask_b32 v10, 0, v10, vcc
  v_add_f32 v11, v11, v10
  v_mov_b32 v10, v11
  s_nop 1
  v_permlane16_swap_b32 v11, v10
  v_add_f32 v11, v11, v10
  v_mov_b32 v10, v11
  s_nop 1
  v_permlane32_swap_b32 v11, v10
  v_add_f32 v11, v11, v10
  s_nop 1
  v_max_f32_dpp v11, v11, v11 row_ror:8 row_mask:0xf bank_mask:0xf
  s_nop 1
  v_max_f32_dpp v11, v11, v11 row_ror:4 row_mask:0xf bank_mask:0xf
  s_nop 1
  v_max_f32_dpp v11, v11, v11 row_ror:2 row_mask:0xf bank_mask:0xf
  s_nop 1
  v_max_f32_dpp v11, v11, v11 row_ror:1 row_mask:0xf bank_mask:0xf
  s_lshl_b32 s46, s84, 2
  s_add_u32 s46, s46, 28340224
  v_mov_b32 v10, 0
  buffer_store_dword v11, v10, s[96:99], s46 offen
front_kernel_nk12:
  s_branch front_kernel_fin
front_kernel_H:
  v_add_u32 v192, s78, v184
  v_add_u32 v193, s78, v185
  v_add_u32 v194, s78, v186
  v_add_u32 v195, s78, v187
  v_add_u32 v196, s78, v188
  v_add_u32 v199, s78, v191
  v_add_u32 v197, s78, v189
  v_add_u32 v198, s78, v190
  ds_read_b128 v[100:103], v192
  ds_read_b128 v[104:107], v194
  ds_read_b64_tr_b16 v[108:109], v196 offset:0
  ds_read_b64_tr_b16 v[110:111], v196 offset:2560
  ds_read_b64_tr_b16 v[112:113], v199 offset:32
  ds_read_b64_tr_b16 v[114:115], v199 offset:2592
  ds_read_b64_tr_b16 v[116:117], v196 offset:64
  ds_read_b64_tr_b16 v[118:119], v196 offset:2624
  ds_read_b64_tr_b16 v[120:121], v199 offset:96
  ds_read_b64_tr_b16 v[122:123], v199 offset:2656
  ds_read_b64_tr_b16 v[124:125], v196 offset:128
  ds_read_b64_tr_b16 v[126:127], v196 offset:2688
  s_waitcnt lgkmcnt(8)
  s_cmp_eq_u32 s79, 0
  s_cbranch_scc1 front_kernel_kr13
  ds_read_b64_tr_b16 v[128:129], v197 offset:0
  ds_read_b64_tr_b16 v[130:131], v197 offset:160
  ds_read_b64_tr_b16 v[132:133], v197 offset:32
  ds_read_b64_tr_b16 v[134:135], v197 offset:192
front_kernel_kr13:
front_kernel_loop1:
  s_waitcnt lgkmcnt(0)
  s_cmp_eq_u32 s79, 0
  s_cbranch_scc1 front_kernel_kr14
  ds_read_b64_tr_b16 v[168:169], v197 offset:1280
  ds_read_b64_tr_b16 v[170:171], v197 offset:1440
  ds_read_b64_tr_b16 v[172:173], v197 offset:1312
  ds_read_b64_tr_b16 v[174:175], v197 offset:1472
front_kernel_kr14:
  v_mfma_f32_16x16x32_bf16 v[16:19], v[108:111], v[100:103], v[16:19]
  ds_read_b128 v[140:143], v193
  ds_read_b128 v[144:147], v195
  v_mfma_f32_16x16x32_bf16 v[36:39], v[108:111], v[104:107], v[36:39]
  ds_read_b64_tr_b16 v[148:149], v196 offset:10240
  ds_read_b64_tr_b16 v[150:151], v196 offset:12800
  v_mfma_f32_16x16x32_bf16 v[56:59], v[108:111], v[96:99], v[56:59]
  ds_read_b64_tr_b16 v[152:153], v199 offset:10272
  ds_read_b64_tr_b16 v[154:155], v199 offset:12832
  v_mfma_f32_16x16x32_bf16 v[20:23], v[112:115], v[100:103], v[20:23]
  ds_read_b64_tr_b16 v[156:157], v196 offset:10304
  ds_read_b64_tr_b16 v[158:159], v196 offset:12864
  v_mfma_f32_16x16x32_bf16 v[40:43], v[112:115], v[104:107], v[40:43]
  ds_read_b64_tr_b16 v[160:161], v199 offset:10336
  ds_read_b64_tr_b16 v[162:163], v199 offset:12896
  v_mfma_f32_16x16x32_bf16 v[60:63], v[112:115], v[96:99], v[60:63]
  ds_read_b64_tr_b16 v[164:165], v196 offset:10368
  ds_read_b64_tr_b16 v[166:167], v196 offset:12928
  v_dot2_f32_bf16 v92, v100, v100, v92
  v_mfma_f32_16x16x32_bf16 v[24:27], v[116:119], v[100:103], v[24:27]
  v_dot2_f32_bf16 v92, v101, v101, v92
  v_mfma_f32_16x16x32_bf16 v[44:47], v[116:119], v[104:107], v[44:47]
  v_dot2_f32_bf16 v92, v102, v102, v92
  v_mfma_f32_16x16x32_bf16 v[64:67], v[116:119], v[96:99], v[64:67]
  v_dot2_f32_bf16 v92, v103, v103, v92
  v_mfma_f32_16x16x32_bf16 v[28:31], v[120:123], v[100:103], v[28:31]
  v_dot2_f32_bf16 v93, v104, v104, v93
  v_mfma_f32_16x16x32_bf16 v[48:51], v[120:123], v[104:107], v[48:51]
  v_dot2_f32_bf16 v93, v105, v105, v93
  v_mfma_f32_16x16x32_bf16 v[68:71], v[120:123], v[96:99], v[68:71]
  v_dot2_f32_bf16 v93, v106, v106, v93
  v_mfma_f32_16x16x32_bf16 v[32:35], v[124:127], v[100:103], v[32:35]
  v_dot2_f32_bf16 v93, v107, v107, v93
  v_mfma_f32_16x16x32_bf16 v[52:55], v[124:127], v[104:107], v[52:55]
  v_mfma_f32_16x16x32_bf16 v[72:75], v[124:127], v[96:99], v[72:75]
  v_mfma_f32_16x16x32_bf16 v[76:79], v[96:99], v[100:103], v[76:79]
  v_mfma_f32_16x16x32_bf16 v[80:83], v[96:99], v[104:107], v[80:83]
  s_cmp_eq_u32 s79, 0
  s_cbranch_scc1 front_kernel_kv15
  v_mfma_f32_16x16x32_bf16 v[84:87], v[100:103], v[128:131], v[84:87]
  v_mfma_f32_16x16x32_bf16 v[88:91], v[100:103], v[132:135], v[88:91]
front_kernel_kv15:
  s_add_u32 s78, s78, 32768
  s_cmp_eq_u32 s78, 131072
  s_cselect_b32 s78, 0, s78
  s_waitcnt lgkmcnt(0)
  s_barrier
  v_add_u32 v192, s78, v184
  v_add_u32 v193, s78, v185
  v_add_u32 v194, s78, v186
  v_add_u32 v195, s78, v187
  v_add_u32 v196, s78, v188
  v_add_u32 v199, s78, v191
  v_add_u32 v197, s78, v189
  v_add_u32 v198, s78, v190
  s_cmp_eq_u32 s79, 0
  s_cbranch_scc1 front_kernel_kr16
  ds_read_b64_tr_b16 v[128:129], v197 offset:0
  ds_read_b64_tr_b16 v[130:131], v197 offset:160
  ds_read_b64_tr_b16 v[132:133], v197 offset:32
  ds_read_b64_tr_b16 v[134:135], v197 offset:192
front_kernel_kr16:
  v_mfma_f32_16x16x32_bf16 v[16:19], v[148:151], v[140:143], v[16:19]
  ds_read_b128 v[100:103], v192
  ds_read_b128 v[104:107], v194
  v_mfma_f32_16x16x32_bf16 v[36:39], v[148:151], v[144:147], v[36:39]
  ds_read_b64_tr_b16 v[108:109], v196 offset:0
  ds_read_b64_tr_b16 v[110:111], v196 offset:2560
  v_mfma_f32_16x16x32_bf16 v[56:59], v[148:151], v[96:99], v[56:59]
  ds_read_b64_tr_b16 v[112:113], v199 offset:32
  ds_read_b64_tr_b16 v[114:115], v199 offset:2592
  v_mfma_f32_16x16x32_bf16 v[20:23], v[152:155], v[140:143], v[20:23]
  ds_read_b64_tr_b16 v[116:117], v196 offset:64
  ds_read_b64_tr_b16 v[118:119], v196 offset:2624
  v_mfma_f32_16x16x32_bf16 v[40:43], v[152:155], v[144:147], v[40:43]
  ds_read_b64_tr_b16 v[120:121], v199 offset:96
  ds_read_b64_tr_b16 v[122:123], v199 offset:2656
  v_mfma_f32_16x16x32_bf16 v[60:63], v[152:155], v[96:99], v[60:63]
  ds_read_b64_tr_b16 v[124:125], v196 offset:128
  ds_read_b64_tr_b16 v[126:127], v196 offset:2688
  v_dot2_f32_bf16 v92, v140, v140, v92
  v_mfma_f32_16x16x32_bf16 v[24:27], v[156:159], v[140:143], v[24:27]
  v_dot2_f32_bf16 v92, v141, v141, v92
  v_mfma_f32_16x16x32_bf16 v[44:47], v[156:159], v[144:147], v[44:47]
  v_dot2_f32_bf16 v92, v142, v142, v92
  v_mfma_f32_16x16x32_bf16 v[64:67], v[156:159], v[96:99], v[64:67]
  v_dot2_f32_bf16 v92, v143, v143, v92
  v_mfma_f32_16x16x32_bf16 v[28:31], v[160:163], v[140:143], v[28:31]
  v_dot2_f32_bf16 v93, v144, v144, v93
  v_mfma_f32_16x16x32_bf16 v[48:51], v[160:163], v[144:147], v[48:51]
  v_dot2_f32_bf16 v93, v145, v145, v93
  v_mfma_f32_16x16x32_bf16 v[68:71], v[160:163], v[96:99], v[68:71]
  v_dot2_f32_bf16 v93, v146, v146, v93
  v_mfma_f32_16x16x32_bf16 v[32:35], v[164:167], v[140:143], v[32:35]
  v_dot2_f32_bf16 v93, v147, v147, v93
  v_mfma_f32_16x16x32_bf16 v[52:55], v[164:167], v[144:147], v[52:55]
  v_mfma_f32_16x16x32_bf16 v[72:75], v[164:167], v[96:99], v[72:75]
  v_mfma_f32_16x16x32_bf16 v[76:79], v[96:99], v[140:143], v[76:79]
  v_mfma_f32_16x16x32_bf16 v[80:83], v[96:99], v[144:147], v[80:83]
  s_cmp_eq_u32 s79, 0
  s_cbranch_scc1 front_kernel_kv17
  v_mfma_f32_16x16x32_bf16 v[84:87], v[140:143], v[168:171], v[84:87]
  v_mfma_f32_16x16x32_bf16 v[88:91], v[140:143], v[172:175], v[88:91]
front_kernel_kv17:
  s_add_u32 s83, s83, 1
  s_cmp_lt_u32 s83, 10
  s_cbranch_scc1 front_kernel_loop1
  s_waitcnt lgkmcnt(0)
  s_nop 7
  s_and_b32 s46, s43, 1
  s_xor_b32 s46, s46, 0
  s_lshl_b32 s47, s44, 1
  s_add_u32 s46, s46, s47
  s_lshl_b32 s47, s40, 2
  s_add_u32 s84, s46, s47
  s_lshl_b32 s47, s84, 4
  v_add_u32 v5, s47, v13
  s_and_b32 s46, s43, 1
  s_xor_b32 s46, s46, 1
  s_lshl_b32 s47, s44, 1
  s_add_u32 s46, s46, s47
  s_lshl_b32 s47, s40, 2
  s_add_u32 s85, s46, s47
  s_lshl_b32 s47, s85, 4
  v_add_u32 v6, s47, v13
  v_mov_b32 v140, 3184710632
  v_mov_b32 v141, v140
  v_mov_b32 v142, 3222493025
  v_mov_b32 v143, v142
  v_mov_b32 v144, 1.0
  v_mov_b32 v145, 1.0
  s_lshr_b32 s70, s43, 1
  s_add_u32 s70, s70, 1
  s_and_b32 s46, s43, 1
  s_sub_u32 s47, 0, s70
  s_cmp_eq_u32 s46, 0
  s_cselect_b32 s70, s70, s47
  s_lshl_b32 s88, s43, 1
  s_add_u32 s88, s88, s45
  s_add_u32 s72, s4, 10403840
  s_addc_u32 s73, s5, 0
  s_mov_b32 s74, 2621440
  s_mov_b32 s75, 0x20000
  v_mov_b32 v7, v92
  s_nop 1
  v_permlane16_swap_b32 v92, v7
  v_add_f32 v92, v92, v7
  v_mov_b32 v7, v92
  s_nop 1
  v_permlane32_swap_b32 v92, v7
  v_add_f32 v92, v92, v7
  v_mul_f32 v146, 3133983949, v76
  v_mul_f32 v148, 986500301, v92
  v_fma_f32 v148, -v146, v146, v148
  v_add_f32 v148, 925353388, v148
  v_rsq_f32 v148, v148
  v_mov_b32 v147, v146
  v_add_u32 v11, s70, v5
  v_lshrrev_b32 v12, 4, v11
  v_mul_u32_u24 v12, 20480, v12
  v_and_b32 v9, 15, v11
  v_lshlrev_b32 v10, 4, v14
  v_add_u32 v9, v9, v10
  v_lshlrev_b32 v9, 4, v9
  v_add_u32 v12, v12, v9
  v_mov_b32 v149, v148
  v_cmp_gt_u32 vcc, 2048, v11
  v_mov_b32 v9, 2130706432
  s_nop 0
  v_cndmask_b32 v12, v9, v12, vcc
  v_cmp_gt_u32 vcc, 32, v2
  s_nop 1
  v_cndmask_b32 v15, v9, v12, vcc
  v_pk_fma_f32 v[16:17], v[146:147], v[56:57], v[16:17]
  v_pk_fma_f32 v[18:19], v[146:147], v[58:59], v[18:19]
  v_pk_fma_f32 v[20:21], v[146:147], v[60:61], v[20:21]
  v_pk_fma_f32 v[22:23], v[146:147], v[62:63], v[22:23]
  v_pk_fma_f32 v[24:25], v[146:147], v[64:65], v[24:25]
  v_pk_fma_f32 v[26:27], v[146:147], v[66:67], v[26:27]
  v_pk_fma_f32 v[28:29], v[146:147], v[68:69], v[28:29]
  v_pk_fma_f32 v[30:31], v[146:147], v[70:71], v[30:31]
  v_pk_fma_f32 v[32:33], v[146:147], v[72:73], v[32:33]
  v_pk_fma_f32 v[34:35], v[146:147], v[74:75], v[34:35]
  v_pk_mul_f32 v[16:17], v[16:17], v[148:149]
  v_pk_mul_f32 v[18:19], v[18:19], v[148:149]
  v_pk_mul_f32 v[20:21], v[20:21], v[148:149]
  v_pk_mul_f32 v[22:23], v[22:23], v[148:149]
  v_pk_mul_f32 v[24:25], v[24:25], v[148:149]
  v_pk_mul_f32 v[26:27], v[26:27], v[148:149]
  v_pk_mul_f32 v[28:29], v[28:29], v[148:149]
  v_pk_mul_f32 v[30:31], v[30:31], v[148:149]
  v_pk_mul_f32 v[32:33], v[32:33], v[148:149]
  v_pk_mul_f32 v[34:35], v[34:35], v[148:149]
  v_pk_mul_f32 v[152:153], v[16:17], v[16:17]
  v_pk_mul_f32 v[154:155], v[18:19], v[18:19]
  v_pk_mul_f32 v[156:157], v[20:21], v[20:21]
  v_pk_mul_f32 v[158:159], v[22:23], v[22:23]
  v_pk_mul_f32 v[160:161], v[24:25], v[24:25]
  v_pk_mul_f32 v[162:163], v[26:27], v[26:27]
  v_pk_mul_f32 v[164:165], v[28:29], v[28:29]
  v_pk_mul_f32 v[166:167], v[30:31], v[30:31]
  v_pk_mul_f32 v[168:169], v[32:33], v[32:33]
  v_pk_mul_f32 v[170:171], v[34:35], v[34:35]
  v_pk_fma_f32 v[152:153], v[152:153], v[140:141], v[142:143]
  v_pk_fma_f32 v[154:155], v[154:155], v[140:141], v[142:143]
  v_pk_fma_f32 v[156:157], v[156:157], v[140:141], v[142:143]
  v_pk_fma_f32 v[158:159], v[158:159], v[140:141], v[142:143]
  v_pk_fma_f32 v[160:161], v[160:161], v[140:141], v[142:143]
  v_pk_fma_f32 v[162:163], v[162:163], v[140:141], v[142:143]
  v_pk_fma_f32 v[164:165], v[164:165], v[140:141], v[142:143]
  v_pk_fma_f32 v[166:167], v[166:167], v[140:141], v[142:143]
  v_pk_fma_f32 v[168:169], v[168:169], v[140:141], v[142:143]
  v_pk_fma_f32 v[170:171], v[170:171], v[140:141], v[142:143]
  v_pk_mul_f32 v[152:153], v[152:153], v[16:17]
  v_pk_mul_f32 v[154:155], v[154:155], v[18:19]
  v_pk_mul_f32 v[156:157], v[156:157], v[20:21]
  v_pk_mul_f32 v[158:159], v[158:159], v[22:23]
  v_pk_mul_f32 v[160:161], v[160:161], v[24:25]
  v_pk_mul_f32 v[162:163], v[162:163], v[26:27]
  v_pk_mul_f32 v[164:165], v[164:165], v[28:29]
  v_pk_mul_f32 v[166:167], v[166:167], v[30:31]
  v_pk_mul_f32 v[168:169], v[168:169], v[32:33]
  v_pk_mul_f32 v[170:171], v[170:171], v[34:35]
  v_exp_f32 v152, v152
  v_exp_f32 v153, v153
  v_exp_f32 v154, v154
  v_exp_f32 v155, v155
  v_exp_f32 v156, v156
  v_exp_f32 v157, v157
  v_exp_f32 v158, v158
  v_exp_f32 v159, v159
  v_exp_f32 v160, v160
  v_exp_f32 v161, v161
  v_exp_f32 v162, v162
  v_exp_f32 v163, v163
  v_exp_f32 v164, v164
  v_exp_f32 v165, v165
  v_exp_f32 v166, v166
  v_exp_f32 v167, v167
  v_exp_f32 v168, v168
  v_exp_f32 v169, v169
  v_exp_f32 v170, v170
  v_exp_f32 v171, v171
  v_pk_add_f32 v[152:153], v[152:153], v[144:145]
  v_pk_add_f32 v[154:155], v[154:155], v[144:145]
  v_pk_add_f32 v[156:157], v[156:157], v[144:145]
  v_pk_add_f32 v[158:159], v[158:159], v[144:145]
  v_pk_add_f32 v[160:161], v[160:161], v[144:145]
  v_pk_add_f32 v[162:163], v[162:163], v[144:145]
  v_pk_add_f32 v[164:165], v[164:165], v[144:145]
  v_pk_add_f32 v[166:167], v[166:167], v[144:145]
  v_pk_add_f32 v[168:169], v[168:169], v[144:145]
  v_pk_add_f32 v[170:171], v[170:171], v[144:145]
  v_rcp_f32 v152, v152
  v_rcp_f32 v153, v153
  v_rcp_f32 v154, v154
  v_rcp_f32 v155, v155
  v_rcp_f32 v156, v156
  v_rcp_f32 v157, v157
  v_rcp_f32 v158, v158
  v_rcp_f32 v159, v159
  v_rcp_f32 v160, v160
  v_rcp_f32 v161, v161
  v_rcp_f32 v162, v162
  v_rcp_f32 v163, v163
  v_rcp_f32 v164, v164
  v_rcp_f32 v165, v165
  v_rcp_f32 v166, v166
  v_rcp_f32 v167, v167
  v_rcp_f32 v168, v168
  v_rcp_f32 v169, v169
  v_rcp_f32 v170, v170
  v_rcp_f32 v171, v171
  v_pk_mul_f32 v[16:17], v[16:17], v[152:153]
  v_pk_mul_f32 v[18:19], v[18:19], v[154:155]
  v_pk_mul_f32 v[20:21], v[20:21], v[156:157]
  v_pk_mul_f32 v[22:23], v[22:23], v[158:159]
  v_pk_mul_f32 v[24:25], v[24:25], v[160:161]
  v_pk_mul_f32 v[26:27], v[26:27], v[162:163]
  v_pk_mul_f32 v[28:29], v[28:29], v[164:165]
  v_pk_mul_f32 v[30:31], v[30:31], v[166:167]
  v_pk_mul_f32 v[32:33], v[32:33], v[168:169]
  v_pk_mul_f32 v[34:35], v[34:35], v[170:171]
  v_cvt_pk_bf16_f32 v100, v16, v17
  v_cvt_pk_bf16_f32 v101, v18, v19
  v_cvt_pk_bf16_f32 v102, v20, v21
  v_cvt_pk_bf16_f32 v103, v22, v23
  v_cvt_pk_bf16_f32 v104, v24, v25
  v_cvt_pk_bf16_f32 v105, v26, v27
  v_cvt_pk_bf16_f32 v106, v28, v29
  v_cvt_pk_bf16_f32 v107, v30, v31
  v_cvt_pk_bf16_f32 v108, v32, v33
  v_cvt_pk_bf16_f32 v109, v34, v35
  s_lshr_b32 s46, s88, 1
  s_mul_i32 s46, s46, 5
  s_and_b32 s47, s88, 1
  s_lshl_b32 s36, s47, 1
  s_add_u32 s36, s36, s46
  s_lshl_b32 s36, s36, 10
  s_add_u32 s37, s46, 4
  s_lshl_b32 s37, s37, 10
  s_lshl_b32 s47, s47, 9
  s_add_u32 s37, s37, s47
  buffer_store_dwordx4 v[100:103], v12, s[72:75], s36 offen sc1
  buffer_store_dwordx4 v[104:107], v12, s[72:75], s36 offen offset:1024 sc1
  v_mov_b32 v172, v108
  v_mov_b32 v173, v109
  v_mov_b32 v174, v108
  v_mov_b32 v175, v109
  s_nop 0
  v_permlane32_swap_b32 v172, v174
  v_permlane32_swap_b32 v173, v175
  buffer_store_dwordx4 v[172:175], v15, s[72:75], s37 offen sc1
  v_mov_b32 v7, v93
  s_nop 1
  v_permlane16_swap_b32 v93, v7
  v_add_f32 v93, v93, v7
  v_mov_b32 v7, v93
  s_nop 1
  v_permlane32_swap_b32 v93, v7
  v_add_f32 v93, v93, v7
  v_mul_f32 v146, 3133983949, v80
  v_mul_f32 v148, 986500301, v93
  v_fma_f32 v148, -v146, v146, v148
  v_add_f32 v148, 925353388, v148
  v_rsq_f32 v148, v148
  v_mov_b32 v147, v146
  v_add_u32 v11, s70, v6
  v_lshrrev_b32 v12, 4, v11
  v_mul_u32_u24 v12, 20480, v12
  v_and_b32 v9, 15, v11
  v_lshlrev_b32 v10, 4, v14
  v_add_u32 v9, v9, v10
  v_lshlrev_b32 v9, 4, v9
  v_add_u32 v12, v12, v9
  v_mov_b32 v149, v148
  v_cmp_gt_u32 vcc, 2048, v11
  v_mov_b32 v9, 2130706432
  s_nop 0
  v_cndmask_b32 v12, v9, v12, vcc
  v_cmp_gt_u32 vcc, 32, v2
  s_nop 1
  v_cndmask_b32 v15, v9, v12, vcc
  v_pk_fma_f32 v[36:37], v[146:147], v[56:57], v[36:37]
  v_pk_fma_f32 v[38:39], v[146:147], v[58:59], v[38:39]
  v_pk_fma_f32 v[40:41], v[146:147], v[60:61], v[40:41]
  v_pk_fma_f32 v[42:43], v[146:147], v[62:63], v[42:43]
  v_pk_fma_f32 v[44:45], v[146:147], v[64:65], v[44:45]
  v_pk_fma_f32 v[46:47], v[146:147], v[66:67], v[46:47]
  v_pk_fma_f32 v[48:49], v[146:147], v[68:69], v[48:49]
  v_pk_fma_f32 v[50:51], v[146:147], v[70:71], v[50:51]
  v_pk_fma_f32 v[52:53], v[146:147], v[72:73], v[52:53]
  v_pk_fma_f32 v[54:55], v[146:147], v[74:75], v[54:55]
  v_pk_mul_f32 v[36:37], v[36:37], v[148:149]
  v_pk_mul_f32 v[38:39], v[38:39], v[148:149]
  v_pk_mul_f32 v[40:41], v[40:41], v[148:149]
  v_pk_mul_f32 v[42:43], v[42:43], v[148:149]
  v_pk_mul_f32 v[44:45], v[44:45], v[148:149]
  v_pk_mul_f32 v[46:47], v[46:47], v[148:149]
  v_pk_mul_f32 v[48:49], v[48:49], v[148:149]
  v_pk_mul_f32 v[50:51], v[50:51], v[148:149]
  v_pk_mul_f32 v[52:53], v[52:53], v[148:149]
  v_pk_mul_f32 v[54:55], v[54:55], v[148:149]
  v_pk_mul_f32 v[152:153], v[36:37], v[36:37]
  v_pk_mul_f32 v[154:155], v[38:39], v[38:39]
  v_pk_mul_f32 v[156:157], v[40:41], v[40:41]
  v_pk_mul_f32 v[158:159], v[42:43], v[42:43]
  v_pk_mul_f32 v[160:161], v[44:45], v[44:45]
  v_pk_mul_f32 v[162:163], v[46:47], v[46:47]
  v_pk_mul_f32 v[164:165], v[48:49], v[48:49]
  v_pk_mul_f32 v[166:167], v[50:51], v[50:51]
  v_pk_mul_f32 v[168:169], v[52:53], v[52:53]
  v_pk_mul_f32 v[170:171], v[54:55], v[54:55]
  v_pk_fma_f32 v[152:153], v[152:153], v[140:141], v[142:143]
  v_pk_fma_f32 v[154:155], v[154:155], v[140:141], v[142:143]
  v_pk_fma_f32 v[156:157], v[156:157], v[140:141], v[142:143]
  v_pk_fma_f32 v[158:159], v[158:159], v[140:141], v[142:143]
  v_pk_fma_f32 v[160:161], v[160:161], v[140:141], v[142:143]
  v_pk_fma_f32 v[162:163], v[162:163], v[140:141], v[142:143]
  v_pk_fma_f32 v[164:165], v[164:165], v[140:141], v[142:143]
  v_pk_fma_f32 v[166:167], v[166:167], v[140:141], v[142:143]
  v_pk_fma_f32 v[168:169], v[168:169], v[140:141], v[142:143]
  v_pk_fma_f32 v[170:171], v[170:171], v[140:141], v[142:143]
  v_pk_mul_f32 v[152:153], v[152:153], v[36:37]
  v_pk_mul_f32 v[154:155], v[154:155], v[38:39]
  v_pk_mul_f32 v[156:157], v[156:157], v[40:41]
  v_pk_mul_f32 v[158:159], v[158:159], v[42:43]
  v_pk_mul_f32 v[160:161], v[160:161], v[44:45]
  v_pk_mul_f32 v[162:163], v[162:163], v[46:47]
  v_pk_mul_f32 v[164:165], v[164:165], v[48:49]
  v_pk_mul_f32 v[166:167], v[166:167], v[50:51]
  v_pk_mul_f32 v[168:169], v[168:169], v[52:53]
  v_pk_mul_f32 v[170:171], v[170:171], v[54:55]
  v_exp_f32 v152, v152
  v_exp_f32 v153, v153
  v_exp_f32 v154, v154
  v_exp_f32 v155, v155
  v_exp_f32 v156, v156
  v_exp_f32 v157, v157
  v_exp_f32 v158, v158
  v_exp_f32 v159, v159
  v_exp_f32 v160, v160
  v_exp_f32 v161, v161
  v_exp_f32 v162, v162
  v_exp_f32 v163, v163
  v_exp_f32 v164, v164
  v_exp_f32 v165, v165
  v_exp_f32 v166, v166
  v_exp_f32 v167, v167
  v_exp_f32 v168, v168
  v_exp_f32 v169, v169
  v_exp_f32 v170, v170
  v_exp_f32 v171, v171
  v_pk_add_f32 v[152:153], v[152:153], v[144:145]
  v_pk_add_f32 v[154:155], v[154:155], v[144:145]
  v_pk_add_f32 v[156:157], v[156:157], v[144:145]
  v_pk_add_f32 v[158:159], v[158:159], v[144:145]
  v_pk_add_f32 v[160:161], v[160:161], v[144:145]
  v_pk_add_f32 v[162:163], v[162:163], v[144:145]
  v_pk_add_f32 v[164:165], v[164:165], v[144:145]
  v_pk_add_f32 v[166:167], v[166:167], v[144:145]
  v_pk_add_f32 v[168:169], v[168:169], v[144:145]
  v_pk_add_f32 v[170:171], v[170:171], v[144:145]
  v_rcp_f32 v152, v152
  v_rcp_f32 v153, v153
  v_rcp_f32 v154, v154
  v_rcp_f32 v155, v155
  v_rcp_f32 v156, v156
  v_rcp_f32 v157, v157
  v_rcp_f32 v158, v158
  v_rcp_f32 v159, v159
  v_rcp_f32 v160, v160
  v_rcp_f32 v161, v161
  v_rcp_f32 v162, v162
  v_rcp_f32 v163, v163
  v_rcp_f32 v164, v164
  v_rcp_f32 v165, v165
  v_rcp_f32 v166, v166
  v_rcp_f32 v167, v167
  v_rcp_f32 v168, v168
  v_rcp_f32 v169, v169
  v_rcp_f32 v170, v170
  v_rcp_f32 v171, v171
  v_pk_mul_f32 v[36:37], v[36:37], v[152:153]
  v_pk_mul_f32 v[38:39], v[38:39], v[154:155]
  v_pk_mul_f32 v[40:41], v[40:41], v[156:157]
  v_pk_mul_f32 v[42:43], v[42:43], v[158:159]
  v_pk_mul_f32 v[44:45], v[44:45], v[160:161]
  v_pk_mul_f32 v[46:47], v[46:47], v[162:163]
  v_pk_mul_f32 v[48:49], v[48:49], v[164:165]
  v_pk_mul_f32 v[50:51], v[50:51], v[166:167]
  v_pk_mul_f32 v[52:53], v[52:53], v[168:169]
  v_pk_mul_f32 v[54:55], v[54:55], v[170:171]
  v_cvt_pk_bf16_f32 v112, v36, v37
  v_cvt_pk_bf16_f32 v113, v38, v39
  v_cvt_pk_bf16_f32 v114, v40, v41
  v_cvt_pk_bf16_f32 v115, v42, v43
  v_cvt_pk_bf16_f32 v116, v44, v45
  v_cvt_pk_bf16_f32 v117, v46, v47
  v_cvt_pk_bf16_f32 v118, v48, v49
  v_cvt_pk_bf16_f32 v119, v50, v51
  v_cvt_pk_bf16_f32 v120, v52, v53
  v_cvt_pk_bf16_f32 v121, v54, v55
  s_lshr_b32 s46, s88, 1
  s_mul_i32 s46, s46, 5
  s_and_b32 s47, s88, 1
  s_lshl_b32 s36, s47, 1
  s_add_u32 s36, s36, s46
  s_lshl_b32 s36, s36, 10
  s_add_u32 s37, s46, 4
  s_lshl_b32 s37, s37, 10
  s_lshl_b32 s47, s47, 9
  s_add_u32 s37, s37, s47
  buffer_store_dwordx4 v[112:115], v12, s[72:75], s36 offen sc1
  buffer_store_dwordx4 v[116:119], v12, s[72:75], s36 offen offset:1024 sc1
  v_mov_b32 v176, v120
  v_mov_b32 v177, v121
  v_mov_b32 v178, v120
  v_mov_b32 v179, v121
  s_nop 0
  v_permlane32_swap_b32 v176, v178
  v_permlane32_swap_b32 v177, v179
  buffer_store_dwordx4 v[176:179], v15, s[72:75], s37 offen sc1
  s_cmp_eq_u32 s79, 0
  s_cbranch_scc1 front_kernel_nv18
  s_lshr_b32 s71, s84, 1
  s_mul_i32 s71, s71, 3072
  s_and_b32 s46, s84, 1
  s_lshl_b32 s46, s46, 10
  s_add_u32 s71, s71, s46
  s_add_u32 s71, s71, 27968512
  v_and_b32 v9, 1, v14
  v_lshlrev_b32 v9, 5, v9
  v_add_u32 v9, v9, v13
  v_lshlrev_b32 v9, 4, v9
  v_lshrrev_b32 v10, 1, v14
  v_lshlrev_b32 v10, 3, v10
  v_add_u32 v9, v9, v10
  v_cvt_pk_bf16_f32 v130, v84, v85
  v_cvt_pk_bf16_f32 v131, v86, v87
  buffer_store_dwordx2 v[130:131], v9, s[96:99], s71 offen
  v_cvt_pk_bf16_f32 v132, v88, v89
  v_cvt_pk_bf16_f32 v133, v90, v91
  v_cmp_gt_u32 vcc, 4, v13
  s_nop 1
  v_cndmask_b32 v132, 0, v132, vcc
  v_cndmask_b32 v133, 0, v133, vcc
  v_mov_b32 v10, 0x3f803f80
  v_and_b32 v11, 11, v13
  v_cmp_eq_u32 vcc, 8, v11
  s_nop 1
  v_cndmask_b32 v132, v132, v10, vcc
  v_cndmask_b32 v133, v133, v10, vcc
  v_cmp_eq_u32 vcc, 9, v13
  s_nop 1
  v_cndmask_b32 v132, v132, v10, vcc
  v_lshrrev_b32 v11, 2, v13
  v_cmp_ne_u32 vcc, 1, v11
  v_add_u32 v9, 256, v9
  v_mov_b32 v10, 2130706432
  v_cndmask_b32 v9, v10, v9, vcc
  buffer_store_dwordx2 v[132:133], v9, s[96:99], s71 offen
front_kernel_nv18:
front_kernel_fin:
front_kernel_end:
  s_endpgm
.globl main_kernel
.p2align 8
.type main_kernel,@function
main_kernel:
  s_cmp_ge_u32 s2, 512
  s_cbranch_scc1 main_kernel_end
  s_load_dwordx2 s[4:5], s[0:1], 104
  s_load_dwordx2 s[6:7], s[0:1], 88
  s_load_dwordx2 s[32:33], s[0:1], 0
  v_lshrrev_b32 v1, 6, v0
  v_and_b32 v2, 63, v0
  v_readfirstlane_b32 s3, v1
  v_lshlrev_b32 v3, 4, v2
  s_cmp_lg_u32 s3, 3
  s_cbranch_scc1 main_kernel_cq1
  s_cmp_ge_u32 s2, 32
  s_cbranch_scc1 main_kernel_cq1
  s_getpc_b64 s[36:37]
main_kernel_cp:
  s_sub_u32 s36, s36, main_kernel_cp-main_kernel
  s_subb_u32 s37, s37, 0
  v_lshlrev_b32 v6, 7, v2
  v_cmp_gt_u32 vcc, code_end-main_kernel, v6
  s_and_saveexec_b64 s[38:39], vcc
  s_cbranch_execz main_kernel_cp2
  global_load_dword v253, v6, s[36:37]
main_kernel_cp2:
  s_mov_b64 exec, s[38:39]
  v_add_u32 v6, 8192, v6
  v_cmp_gt_u32 vcc, code_end-main_kernel, v6
  s_and_saveexec_b64 s[38:39], vcc
  s_cbranch_execz main_kernel_cp3
  global_load_dword v253, v6, s[36:37]
main_kernel_cp3:
  s_mov_b64 exec, s[38:39]
  v_add_u32 v6, 8192, v6
  v_cmp_gt_u32 vcc, code_end-main_kernel, v6
  s_and_saveexec_b64 s[38:39], vcc
  s_cbranch_execz main_kernel_cp4
  global_load_dword v253, v6, s[36:37]
main_kernel_cp4:
  s_mov_b64 exec, s[38:39]
  v_add_u32 v6, 8192, v6
  v_cmp_gt_u32 vcc, code_end-main_kernel, v6
  s_and_saveexec_b64 s[38:39], vcc
  s_cbranch_execz main_kernel_cp5
  global_load_dword v253, v6, s[36:37]
main_kernel_cp5:
  s_mov_b64 exec, s[38:39]
main_kernel_cq1:
  s_cmp_ge_u32 s2, 256
  s_cbranch_scc1 main_kernel_B
  s_sub_u32 s46, s2, 0
  s_and_b32 s47, s46, 7
  s_lshr_b32 s46, s46, 3
  s_lshr_b32 s40, s46, 3
  s_lshl_b32 s47, s47, 2
  s_add_u32 s40, s40, s47
  s_and_b32 s41, s46, 7
  s_setprio 1
  s_and_b32 s42, s3, 1
  s_lshr_b32 s43, s3, 1
  v_and_b32 v7, 31, v2
  v_lshlrev_b32 v8, 3, v7
  s_lshl_b32 s46, s40, 6
  s_lshl_b32 s47, s43, 5
  s_add_u32 s46, s46, s47
  v_add_u32 v9, s46, v7
  v_lshlrev_b32 v10, 2, v9
  v_lshlrev_b32 v11, 3, v2
  s_mul_i32 s44, s3, 3072
  s_waitcnt lgkmcnt(0)
  s_add_u32 s12, s4, 25346048
  s_addc_u32 s13, s5, 0
  s_mov_b32 s14, 2621440
  s_mov_b32 s15, 0x20000
  s_add_u32 s8, s4, 27967488
  s_addc_u32 s9, s5, 0
  s_mov_b32 s10, 196608
  s_mov_b32 s11, 0x20000
  s_add_u32 s16, s4, 28340224
  s_addc_u32 s17, s5, 0
  s_mov_b32 s18, 512
  s_mov_b32 s19, 0x20000
  s_add_u32 s20, s4, 28180480
  s_addc_u32 s21, s5, 0
  s_mov_b32 s22, 8192
  s_mov_b32 s23, 0x20000
  s_add_u32 s24, s4, 15646720
  s_addc_u32 s25, s5, 0
  s_mov_b32 s26, 2621440
  s_mov_b32 s27, 0x20000
  s_add_u32 s28, s4, 28344320
  s_addc_u32 s29, s5, 0
  s_mov_b32 s30, 4096
  s_mov_b32 s31, 0x20000
  s_lshl_b32 s46, s41, 2
  s_lshl_b32 s47, s42, 1
  s_add_u32 s46, s46, s47
  s_lshl_b32 s46, s46, 6
  s_lshl_b32 s47, s40, 1
  s_add_u32 s46, s46, s47
  s_add_u32 s46, s46, s43
  s_mul_i32 s46, s46, 1280
  buffer_load_dwordx4 v[16:19], v3, s[12:15], s46 offen
  buffer_load_dwordx2 v[20:21], v8, s[12:15], s46 offen offset:1024
  s_add_u32 s46, s46, 81920
  buffer_load_dwordx4 v[24:27], v3, s[12:15], s46 offen
  buffer_load_dwordx2 v[28:29], v8, s[12:15], s46 offen offset:1024
  buffer_load_dwordx2 v[64:65], v11, s[16:19], 0 offen
  buffer_load_dword v12, v10, s[20:23], 0 offen
  s_add_u32 s45, s44, 0
  s_add_u32 m0, s44, 0
  s_nop 0
  buffer_load_dwordx4 v3, s[8:11], s45 offen offset:0 lds
  buffer_load_dwordx4 v3, s[8:11], s45 offen offset:1024 lds
  buffer_load_dwordx4 v3, s[8:11], s45 offen offset:2048 lds
  s_add_u32 s45, s44, 12288
  s_add_u32 m0, s44, 12288
  s_nop 0
  buffer_load_dwordx4 v3, s[8:11], s45 offen offset:0 lds
  buffer_load_dwordx4 v3, s[8:11], s45 offen offset:1024 lds
  buffer_load_dwordx4 v3, s[8:11], s45 offen offset:2048 lds
  s_add_u32 s45, s44, 24576
  s_add_u32 m0, s44, 24576
  s_nop 0
  buffer_load_dwordx4 v3, s[8:11], s45 offen offset:0 lds
  buffer_load_dwordx4 v3, s[8:11], s45 offen offset:1024 lds
  buffer_load_dwordx4 v3, s[8:11], s45 offen offset:2048 lds
  v_mov_b32 v32, 0
  v_mov_b32 v33, 0
  v_mov_b32 v34, 0
  v_mov_b32 v35, 0
  v_mov_b32 v36, 0
  v_mov_b32 v37, 0
  v_mov_b32 v38, 0
  v_mov_b32 v39, 0
  v_mov_b32 v40, 0
  v_mov_b32 v41, 0
  v_mov_b32 v42, 0
  v_mov_b32 v43, 0
  v_mov_b32 v44, 0
  v_mov_b32 v45, 0
  v_mov_b32 v46, 0
  v_mov_b32 v47, 0
  v_mov_b32 v48, 0
  v_mov_b32 v49, 0
  v_mov_b32 v50, 0
  v_mov_b32 v51, 0
  v_mov_b32 v52, 0
  v_mov_b32 v53, 0
  v_mov_b32 v54, 0
  v_mov_b32 v55, 0
  v_mov_b32 v56, 0
  v_mov_b32 v57, 0
  v_mov_b32 v58, 0
  v_mov_b32 v59, 0
  v_mov_b32 v60, 0
  v_mov_b32 v61, 0
  v_mov_b32 v62, 0
  v_mov_b32 v63, 0
  v_lshrrev_b32 v14, 3, v7
  v_lshlrev_b32 v15, 9, v14
  v_add_u32 v15, 1344, v15
  v_and_b32 v14, 7, v7
  v_lshlrev_b32 v14, 3, v14
  v_add_u32 v15, v15, v14
  v_cmp_gt_u32 vcc, 32, v2
  v_mov_b32 v14, 1424
  s_nop 0
  v_cndmask_b32 v15, v14, v15, vcc
  v_mov_b32 v5, v3
  v_mov_b32 v6, v15
  v_mov_b32 v108, 0
  v_mov_b32 v109, 0
  v_mov_b32 v110, 0
  v_mov_b32 v111, 0
  v_mov_b32 v92, 0
  v_mov_b32 v93, 0
  v_mov_b32 v94, 0
  v_mov_b32 v95, 0
  v_mov_b32 v140, 0
  v_mov_b32 v141, 0
  v_mov_b32 v142, 0
  v_mov_b32 v143, 0
  s_waitcnt vmcnt(9)
  v_max_f32 v64, v64, v65
  s_nop 1
  v_max_f32_dpp v64, v64, v64 row_ror:8 row_mask:0xf bank_mask:0xf
  s_nop 1
  v_max_f32_dpp v64, v64, v64 row_ror:4 row_mask:0xf bank_mask:0xf
  s_nop 1
  v_max_f32_dpp v64, v64, v64 row_ror:2 row_mask:0xf bank_mask:0xf
  s_nop 1
  v_max_f32_dpp v64, v64, v64 row_ror:1 row_mask:0xf bank_mask:0xf
  v_mov_b32 v65, v64
  s_nop 1
  v_permlane16_swap_b32 v64, v65
  v_max_f32 v64, v64, v65
  v_mov_b32 v65, v64
  s_nop 1
  v_permlane32_swap_b32 v64, v65
  v_max_f32 v64, v64, v65
  v_cndmask_b32 v68, 0, v20, vcc
  v_cndmask_b32 v69, 0, v21, vcc
  v_dot2_f32_bf16 v66, v16, v16, 0
  v_dot2_f32_bf16 v66, v17, v17, v66
  v_dot2_f32_bf16 v66, v18, v18, v66
  v_dot2_f32_bf16 v66, v19, v19, v66
  v_dot2_f32_bf16 v66, v68, v68, v66
  v_dot2_f32_bf16 v66, v69, v69, v66
  v_cndmask_b32 v72, 0, v28, vcc
  v_cndmask_b32 v73, 0, v29, vcc
  v_dot2_f32_bf16 v70, v24, v24, 0
  v_dot2_f32_bf16 v70, v25, v25, v70
  v_dot2_f32_bf16 v70, v26, v26, v70
  v_dot2_f32_bf16 v70, v27, v27, v70
  v_dot2_f32_bf16 v70, v72, v72, v70
  v_dot2_f32_bf16 v70, v73, v73, v70
  v_mov_b32 v67, v66
  s_nop 1
  v_permlane32_swap_b32 v66, v67
  v_add_f32 v66, v66, v67
  v_mul_f32 v66, v66, v64
  v_sqrt_f32 v66, v66
  v_mov_b32 v71, v70
  s_nop 1
  v_permlane32_swap_b32 v70, v71
  v_add_f32 v70, v70, v71
  v_mul_f32 v70, v70, v64
  v_sqrt_f32 v70, v70
  v_mul_f32 v66, 3212920750, v66
  v_and_b32 v67, 0xffff0000, v66
  v_sub_f32 v68, v66, v67
  v_cvt_pk_bf16_f32 v68, v67, v68
  v_cndmask_b32 v20, v68, v20, vcc
  v_cndmask_b32 v21, 0, v21, vcc
  v_mul_f32 v70, 3212920750, v70
  v_and_b32 v71, 0xffff0000, v70
  v_sub_f32 v72, v70, v71
  v_cvt_pk_bf16_f32 v72, v71, v72
  v_cndmask_b32 v28, v72, v28, vcc
  v_cndmask_b32 v29, 0, v29, vcc
  s_waitcnt vmcnt(6)
  s_barrier
  ds_read_b128 v[112:115], v5 offset:0
  ds_read_b64 v[116:117], v6 offset:0
  ds_read_b128 v[128:131], v5 offset:1024
  ds_read_b128 v[132:135], v5 offset:2048
  s_waitcnt lgkmcnt(2)
  v_mfma_f32_32x32x16_bf16 v[64:79], v[112:115], v[16:19], 0
  v_mfma_f32_32x32x8_bf16 v[64:79], v[116:117], v[20:21], v[64:79]
  s_mov_b32 s52, 0
  s_mov_b32 s53, 0
  s_add_u32 s54, s44, 36864
  s_add_u32 s56, s44, 36864
  s_nop 7
  s_nop 3
main_kernel_aloop:
  v_exp_f32 v64, v64
  v_exp_f32 v65, v65
  v_cvt_pk_bf16_f32 v110, v92, v93
  v_exp_f32 v66, v66
  v_exp_f32 v67, v67
  v_cvt_pk_bf16_f32 v111, v94, v95
  s_waitcnt lgkmcnt(0)
  v_mfma_f32_32x32x16_bf16 v[80:95], v[112:115], v[24:27], 0
  ds_read_b128 v[120:123], v5 offset:3072
  v_exp_f32 v68, v68
  v_exp_f32 v69, v69
  v_cvt_pk_bf16_f32 v96, v64, v65
  v_exp_f32 v70, v70
  v_exp_f32 v71, v71
  v_cvt_pk_bf16_f32 v97, v66, v67
  v_mfma_f32_32x32x8_bf16 v[80:95], v[116:117], v[28:29], v[80:95]
  ds_read_b64 v[124:125], v6 offset:3072
  v_exp_f32 v72, v72
  v_exp_f32 v73, v73
  v_cvt_pk_bf16_f32 v98, v68, v69
  v_exp_f32 v74, v74
  v_exp_f32 v75, v75
  v_cvt_pk_bf16_f32 v99, v70, v71
  v_mfma_f32_32x32x16_bf16 v[48:63], v[140:143], v[108:111], v[48:63]
  ds_read_b128 v[140:143], v5 offset:5120
  v_exp_f32 v76, v76
  v_exp_f32 v77, v77
  v_cvt_pk_bf16_f32 v100, v72, v73
  v_exp_f32 v78, v78
  v_exp_f32 v79, v79
  v_cvt_pk_bf16_f32 v101, v74, v75
  v_mfma_f32_32x32x16_bf16 v[32:47], v[128:131], v[96:99], v[32:47]
  ds_read_b128 v[136:139], v5 offset:4096
  v_exp_f32 v80, v80
  v_exp_f32 v81, v81
  v_cvt_pk_bf16_f32 v102, v76, v77
  v_exp_f32 v82, v82
  v_exp_f32 v83, v83
  v_cvt_pk_bf16_f32 v103, v78, v79
  s_waitcnt lgkmcnt(2)
  v_mfma_f32_32x32x16_bf16 v[64:79], v[120:123], v[16:19], 0
  s_cmp_lt_u32 s54, 196608
  s_cselect_b32 s55, s54, 2130706432
  s_mov_b32 m0, s56
  v_exp_f32 v84, v84
  v_exp_f32 v85, v85
  v_cvt_pk_bf16_f32 v104, v80, v81
  v_exp_f32 v86, v86
  v_exp_f32 v87, v87
  v_cvt_pk_bf16_f32 v105, v82, v83
  v_mfma_f32_32x32x8_bf16 v[64:79], v[124:125], v[20:21], v[64:79]
  buffer_load_dwordx4 v3, s[8:11], s55 offen offset:0 lds
  v_exp_f32 v88, v88
  v_exp_f32 v89, v89
  v_cvt_pk_bf16_f32 v106, v84, v85
  v_exp_f32 v90, v90
  v_exp_f32 v91, v91
  v_cvt_pk_bf16_f32 v107, v86, v87
  v_mfma_f32_32x32x16_bf16 v[32:47], v[132:135], v[100:103], v[32:47]
  v_exp_f32 v92, v92
  v_exp_f32 v93, v93
  v_cvt_pk_bf16_f32 v108, v88, v89
  v_exp_f32 v94, v94
  v_exp_f32 v95, v95
  v_cvt_pk_bf16_f32 v109, v90, v91
  v_mfma_f32_32x32x16_bf16 v[48:63], v[128:131], v[104:107], v[48:63]
  v_exp_f32 v64, v64
  v_exp_f32 v65, v65
  v_cvt_pk_bf16_f32 v110, v92, v93
  v_exp_f32 v66, v66
  v_exp_f32 v67, v67
  v_cvt_pk_bf16_f32 v111, v94, v95
  s_waitcnt lgkmcnt(0)
  v_mfma_f32_32x32x16_bf16 v[80:95], v[120:123], v[24:27], 0
  ds_read_b128 v[112:115], v5 offset:6144
  v_exp_f32 v68, v68
  v_exp_f32 v69, v69
  v_cvt_pk_bf16_f32 v96, v64, v65
  v_exp_f32 v70, v70
  v_exp_f32 v71, v71
  v_cvt_pk_bf16_f32 v97, v66, v67
  v_mfma_f32_32x32x8_bf16 v[80:95], v[124:125], v[28:29], v[80:95]
  ds_read_b64 v[116:117], v6 offset:6144
  v_exp_f32 v72, v72
  v_exp_f32 v73, v73
  v_cvt_pk_bf16_f32 v98, v68, v69
  v_exp_f32 v74, v74
  v_exp_f32 v75, v75
  v_cvt_pk_bf16_f32 v99, v70, v71
  v_mfma_f32_32x32x16_bf16 v[48:63], v[132:135], v[108:111], v[48:63]
  ds_read_b128 v[132:135], v5 offset:8192
  v_exp_f32 v76, v76
  v_exp_f32 v77, v77
  v_cvt_pk_bf16_f32 v100, v72, v73
  v_exp_f32 v78, v78
  v_exp_f32 v79, v79
  v_cvt_pk_bf16_f32 v101, v74, v75
  v_mfma_f32_32x32x16_bf16 v[32:47], v[136:139], v[96:99], v[32:47]
  ds_read_b128 v[128:131], v5 offset:7168
  v_exp_f32 v80, v80
  v_exp_f32 v81, v81
  v_cvt_pk_bf16_f32 v102, v76, v77
  v_exp_f32 v82, v82
  v_exp_f32 v83, v83
  v_cvt_pk_bf16_f32 v103, v78, v79
  s_waitcnt lgkmcnt(2)
  v_mfma_f32_32x32x16_bf16 v[64:79], v[112:115], v[16:19], 0
  v_exp_f32 v84, v84
  v_exp_f32 v85, v85
  v_cvt_pk_bf16_f32 v104, v80, v81
  v_exp_f32 v86, v86
  v_exp_f32 v87, v87
  v_cvt_pk_bf16_f32 v105, v82, v83
  v_mfma_f32_32x32x8_bf16 v[64:79], v[116:117], v[20:21], v[64:79]
  buffer_load_dwordx4 v3, s[8:11], s55 offen offset:1024 lds
  v_exp_f32 v88, v88
  v_exp_f32 v89, v89
  v_cvt_pk_bf16_f32 v106, v84, v85
  v_exp_f32 v90, v90
  v_exp_f32 v91, v91
  v_cvt_pk_bf16_f32 v107, v86, v87
  v_mfma_f32_32x32x16_bf16 v[32:47], v[140:143], v[100:103], v[32:47]
  v_exp_f32 v92, v92
  v_exp_f32 v93, v93
  v_cvt_pk_bf16_f32 v108, v88, v89
  v_exp_f32 v94, v94
  v_exp_f32 v95, v95
  v_cvt_pk_bf16_f32 v109, v90, v91
  v_mfma_f32_32x32x16_bf16 v[48:63], v[136:139], v[104:107], v[48:63]
  v_exp_f32 v64, v64
  v_exp_f32 v65, v65
  v_cvt_pk_bf16_f32 v110, v92, v93
  v_exp_f32 v66, v66
  v_exp_f32 v67, v67
  v_cvt_pk_bf16_f32 v111, v94, v95
  s_waitcnt lgkmcnt(0)
  v_mfma_f32_32x32x16_bf16 v[80:95], v[112:115], v[24:27], 0
  ds_read_b128 v[120:123], v5 offset:9216
  v_exp_f32 v68, v68
  v_exp_f32 v69, v69
  v_cvt_pk_bf16_f32 v96, v64, v65
  v_exp_f32 v70, v70
  v_exp_f32 v71, v71
  v_cvt_pk_bf16_f32 v97, v66, v67
  v_mfma_f32_32x32x8_bf16 v[80:95], v[116:117], v[28:29], v[80:95]
  ds_read_b64 v[124:125], v6 offset:9216
  v_exp_f32 v72, v72
  v_exp_f32 v73, v73
  v_cvt_pk_bf16_f32 v98, v68, v69
  v_exp_f32 v74, v74
  v_exp_f32 v75, v75
  v_cvt_pk_bf16_f32 v99, v70, v71
  v_mfma_f32_32x32x16_bf16 v[48:63], v[140:143], v[108:111], v[48:63]
  ds_read_b128 v[140:143], v5 offset:11264
  v_exp_f32 v76, v76
  v_exp_f32 v77, v77
  v_cvt_pk_bf16_f32 v100, v72, v73
  v_exp_f32 v78, v78
  v_exp_f32 v79, v79
  v_cvt_pk_bf16_f32 v101, v74, v75
  v_mfma_f32_32x32x16_bf16 v[32:47], v[128:131], v[96:99], v[32:47]
  ds_read_b128 v[136:139], v5 offset:10240
  v_exp_f32 v80, v80
  v_exp_f32 v81, v81
  v_cvt_pk_bf16_f32 v102, v76, v77
  v_exp_f32 v82, v82
  v_exp_f32 v83, v83
  v_cvt_pk_bf16_f32 v103, v78, v79
  s_waitcnt lgkmcnt(2)
  v_mfma_f32_32x32x16_bf16 v[64:79], v[120:123], v[16:19], 0
  v_exp_f32 v84, v84
  v_exp_f32 v85, v85
  v_cvt_pk_bf16_f32 v104, v80, v81
  v_exp_f32 v86, v86
  v_exp_f32 v87, v87
  v_cvt_pk_bf16_f32 v105, v82, v83
  v_mfma_f32_32x32x8_bf16 v[64:79], v[124:125], v[20:21], v[64:79]
  buffer_load_dwordx4 v3, s[8:11], s55 offen offset:2048 lds
  v_exp_f32 v88, v88
  v_exp_f32 v89, v89
  v_cvt_pk_bf16_f32 v106, v84, v85
  v_exp_f32 v90, v90
  v_exp_f32 v91, v91
  v_cvt_pk_bf16_f32 v107, v86, v87
  v_mfma_f32_32x32x16_bf16 v[32:47], v[132:135], v[100:103], v[32:47]
  s_add_u32 s54, s54, 12288
  s_add_u32 s56, s56, 12288
  v_exp_f32 v92, v92
  v_exp_f32 v93, v93
  v_cvt_pk_bf16_f32 v108, v88, v89
  v_exp_f32 v94, v94
  v_exp_f32 v95, v95
  v_cvt_pk_bf16_f32 v109, v90, v91
  v_mfma_f32_32x32x16_bf16 v[48:63], v[128:131], v[104:107], v[48:63]
  s_sub_u32 s57, s56, s44
  s_cmp_eq_u32 s57, 49152
  s_cselect_b32 s56, s44, s56
  v_exp_f32 v64, v64
  v_exp_f32 v65, v65
  v_cvt_pk_bf16_f32 v110, v92, v93
  v_exp_f32 v66, v66
  v_exp_f32 v67, v67
  s_add_u32 s53, s53, 12288
  s_cmp_eq_u32 s53, 49152
  s_cselect_b32 s53, 0, s53
  v_cvt_pk_bf16_f32 v111, v94, v95
  v_add_u32 v5, s53, v3
  v_add_u32 v6, s53, v15
  s_waitcnt vmcnt(6) lgkmcnt(0)
  s_barrier
  v_mfma_f32_32x32x16_bf16 v[80:95], v[120:123], v[24:27], 0
  ds_read_b128 v[112:115], v5 offset:0
  v_exp_f32 v68, v68
  v_exp_f32 v69, v69
  v_cvt_pk_bf16_f32 v96, v64, v65
  v_exp_f32 v70, v70
  v_exp_f32 v71, v71
  v_cvt_pk_bf16_f32 v97, v66, v67
  v_mfma_f32_32x32x8_bf16 v[80:95], v[124:125], v[28:29], v[80:95]
  ds_read_b64 v[116:117], v6 offset:0
  v_exp_f32 v72, v72
  v_exp_f32 v73, v73
  v_cvt_pk_bf16_f32 v98, v68, v69
  v_exp_f32 v74, v74
  v_exp_f32 v75, v75
  v_cvt_pk_bf16_f32 v99, v70, v71
  v_mfma_f32_32x32x16_bf16 v[48:63], v[132:135], v[108:111], v[48:63]
  ds_read_b128 v[132:135], v5 offset:2048
  v_exp_f32 v76, v76
  v_exp_f32 v77, v77
  v_cvt_pk_bf16_f32 v100, v72, v73
  v_exp_f32 v78, v78
  v_exp_f32 v79, v79
  v_cvt_pk_bf16_f32 v101, v74, v75
  v_mfma_f32_32x32x16_bf16 v[32:47], v[136:139], v[96:99], v[32:47]
  ds_read_b128 v[128:131], v5 offset:1024
  v_exp_f32 v80, v80
  v_exp_f32 v81, v81
  v_cvt_pk_bf16_f32 v102, v76, v77
  v_exp_f32 v82, v82
  v_exp_f32 v83, v83
  v_cvt_pk_bf16_f32 v103, v78, v79
  s_waitcnt lgkmcnt(2)
  v_mfma_f32_32x32x16_bf16 v[64:79], v[112:115], v[16:19], 0
  v_exp_f32 v84, v84
  v_exp_f32 v85, v85
  v_cvt_pk_bf16_f32 v104, v80, v81
  v_exp_f32 v86, v86
  v_exp_f32 v87, v87
  v_cvt_pk_bf16_f32 v105, v82, v83
  v_mfma_f32_32x32x8_bf16 v[64:79], v[116:117], v[20:21], v[64:79]
  v_exp_f32 v88, v88
  v_exp_f32 v89, v89
  v_cvt_pk_bf16_f32 v106, v84, v85
  v_exp_f32 v90, v90
  v_exp_f32 v91, v91
  v_cvt_pk_bf16_f32 v107, v86, v87
  v_mfma_f32_32x32x16_bf16 v[32:47], v[140:143], v[100:103], v[32:47]
  v_exp_f32 v92, v92
  v_exp_f32 v93, v93
  v_cvt_pk_bf16_f32 v108, v88, v89
  v_exp_f32 v94, v94
  v_exp_f32 v95, v95
  v_cvt_pk_bf16_f32 v109, v90, v91
  v_mfma_f32_32x32x16_bf16 v[48:63], v[136:139], v[104:107], v[48:63]
  s_add_u32 s52, s52, 1
  s_cmp_lt_u32 s52, 16
  s_cbranch_scc1 main_kernel_aloop
  v_cvt_pk_bf16_f32 v110, v92, v93
  v_cvt_pk_bf16_f32 v111, v94, v95
  s_nop 1
  v_mfma_f32_32x32x16_bf16 v[48:63], v[140:143], v[108:111], v[48:63]
  s_nop 7
  s_nop 3
  s_mov_b32 s58, 394264576
  v_cmp_nle_f32 vcc, s58, v44
  v_cmp_nle_f32 s[60:61], s58, v60
  s_or_b64 vcc, vcc, s[60:61]
  s_cmp_eq_u64 vcc, 0
  s_cbranch_scc1 main_kernel_fast
  s_waitcnt vmcnt(0) lgkmcnt(0)
  v_cmp_gt_u32 vcc, 32, v2
  s_nop 1
  v_cndmask_b32 v144, 0, v20, vcc
  v_cndmask_b32 v145, 0, v21, vcc
  v_mov_b32 v148, 0xff800000
  v_cndmask_b32 v146, 0, v28, vcc
  v_cndmask_b32 v147, 0, v29, vcc
  v_mov_b32 v149, 0xff800000
  s_mov_b32 s59, 0
main_kernel_slow1:
  buffer_load_dwordx4 v[112:115], v3, s[8:11], s59 offen
  buffer_load_dwordx2 v[116:117], v15, s[8:11], s59 offen
  s_waitcnt vmcnt(0)
  v_mfma_f32_32x32x16_bf16 v[64:79], v[112:115], v[16:19], 0
  v_mfma_f32_32x32x8_bf16 v[64:79], v[116:117], v[144:145], v[64:79]
  v_mfma_f32_32x32x16_bf16 v[80:95], v[112:115], v[24:27], 0
  v_mfma_f32_32x32x8_bf16 v[80:95], v[116:117], v[146:147], v[80:95]
  s_nop 7
  s_nop 7
  v_max3_f32 v148, v148, v64, v65
  v_max3_f32 v148, v148, v66, v67
  v_max3_f32 v148, v148, v68, v69
  v_max3_f32 v148, v148, v70, v71
  v_max3_f32 v148, v148, v72, v73
  v_max3_f32 v148, v148, v74, v75
  v_max3_f32 v148, v148, v76, v77
  v_max3_f32 v148, v148, v78, v79
  v_max3_f32 v149, v149, v80, v81
  v_max3_f32 v149, v149, v82, v83
  v_max3_f32 v149, v149, v84, v85
  v_max3_f32 v149, v149, v86, v87
  v_max3_f32 v149, v149, v88, v89
  v_max3_f32 v149, v149, v90, v91
  v_max3_f32 v149, v149, v92, v93
  v_max3_f32 v149, v149, v94, v95
  s_add_u32 s59, s59, 3072
  s_cmp_lt_u32 s59, 196608
  s_cbranch_scc1 main_kernel_slow1
  v_mov_b32 v150, v148
  s_nop 1
  v_permlane32_swap_b32 v148, v150
  v_max_f32 v148, v148, v150
  v_sub_f32 v150, 0, v148
  v_and_b32 v151, 0xffff0000, v150
  v_sub_f32 v152, v150, v151
  v_cvt_pk_bf16_f32 v152, v151, v152
  v_cndmask_b32 v20, v152, v20, vcc
  v_mov_b32 v32, 0
  v_mov_b32 v33, 0
  v_mov_b32 v34, 0
  v_mov_b32 v35, 0
  v_mov_b32 v36, 0
  v_mov_b32 v37, 0
  v_mov_b32 v38, 0
  v_mov_b32 v39, 0
  v_mov_b32 v40, 0
  v_mov_b32 v41, 0
  v_mov_b32 v42, 0
  v_mov_b32 v43, 0
  v_mov_b32 v44, 0
  v_mov_b32 v45, 0
  v_mov_b32 v46, 0
  v_mov_b32 v47, 0
  v_mov_b32 v150, v149
  s_nop 1
  v_permlane32_swap_b32 v149, v150
  v_max_f32 v149, v149, v150
  v_sub_f32 v150, 0, v149
  v_and_b32 v151, 0xffff0000, v150
  v_sub_f32 v152, v150, v151
  v_cvt_pk_bf16_f32 v152, v151, v152
  v_cndmask_b32 v28, v152, v28, vcc
  v_mov_b32 v48, 0
  v_mov_b32 v49, 0
  v_mov_b32 v50, 0
  v_mov_b32 v51, 0
  v_mov_b32 v52, 0
  v_mov_b32 v53, 0
  v_mov_b32 v54, 0
  v_mov_b32 v55, 0
  v_mov_b32 v56, 0
  v_mov_b32 v57, 0
  v_mov_b32 v58, 0
  v_mov_b32 v59, 0
  v_mov_b32 v60, 0
  v_mov_b32 v61, 0
  v_mov_b32 v62, 0
  v_mov_b32 v63, 0
  s_mov_b32 s59, 0
main_kernel_slow2:
  buffer_load_dwordx4 v[112:115], v3, s[8:11], s59 offen
  buffer_load_dwordx2 v[116:117], v15, s[8:11], s59 offen
  buffer_load_dwordx4 v[128:131], v3, s[8:11], s59 offen offset:1024
  buffer_load_dwordx4 v[132:135], v3, s[8:11], s59 offen offset:2048
  s_waitcnt vmcnt(0)
  v_mfma_f32_32x32x16_bf16 v[64:79], v[112:115], v[16:19], 0
  v_mfma_f32_32x32x8_bf16 v[64:79], v[116:117], v[20:21], v[64:79]
  v_mfma_f32_32x32x16_bf16 v[80:95], v[112:115], v[24:27], 0
  v_mfma_f32_32x32x8_bf16 v[80:95], v[116:117], v[28:29], v[80:95]
  s_nop 7
  s_nop 7
  v_exp_f32 v64, v64
  v_exp_f32 v65, v65
  v_exp_f32 v66, v66
  v_exp_f32 v67, v67
  v_exp_f32 v68, v68
  v_exp_f32 v69, v69
  v_exp_f32 v70, v70
  v_exp_f32 v71, v71
  v_exp_f32 v72, v72
  v_exp_f32 v73, v73
  v_exp_f32 v74, v74
  v_exp_f32 v75, v75
  v_exp_f32 v76, v76
  v_exp_f32 v77, v77
  v_exp_f32 v78, v78
  v_exp_f32 v79, v79
  s_nop 1
  v_cvt_pk_bf16_f32 v96, v64, v65
  v_cvt_pk_bf16_f32 v97, v66, v67
  v_cvt_pk_bf16_f32 v98, v68, v69
  v_cvt_pk_bf16_f32 v99, v70, v71
  v_cvt_pk_bf16_f32 v100, v72, v73
  v_cvt_pk_bf16_f32 v101, v74, v75
  v_cvt_pk_bf16_f32 v102, v76, v77
  v_cvt_pk_bf16_f32 v103, v78, v79
  v_exp_f32 v80, v80
  v_exp_f32 v81, v81
  v_exp_f32 v82, v82
  v_exp_f32 v83, v83
  v_exp_f32 v84, v84
  v_exp_f32 v85, v85
  v_exp_f32 v86, v86
  v_exp_f32 v87, v87
  v_exp_f32 v88, v88
  v_exp_f32 v89, v89
  v_exp_f32 v90, v90
  v_exp_f32 v91, v91
  v_exp_f32 v92, v92
  v_exp_f32 v93, v93
  v_exp_f32 v94, v94
  v_exp_f32 v95, v95
  s_nop 1
  v_cvt_pk_bf16_f32 v104, v80, v81
  v_cvt_pk_bf16_f32 v105, v82, v83
  v_cvt_pk_bf16_f32 v106, v84, v85
  v_cvt_pk_bf16_f32 v107, v86, v87
  v_cvt_pk_bf16_f32 v108, v88, v89
  v_cvt_pk_bf16_f32 v109, v90, v91
  v_cvt_pk_bf16_f32 v110, v92, v93
  v_cvt_pk_bf16_f32 v111, v94, v95
  s_nop 1
  v_mfma_f32_32x32x16_bf16 v[32:47], v[128:131], v[96:99], v[32:47]
  v_mfma_f32_32x32x16_bf16 v[32:47], v[132:135], v[100:103], v[32:47]
  v_mfma_f32_32x32x16_bf16 v[48:63], v[128:131], v[104:107], v[48:63]
  v_mfma_f32_32x32x16_bf16 v[48:63], v[132:135], v[108:111], v[48:63]
  s_nop 7
  s_nop 7
  s_add_u32 s59, s59, 3072
  s_cmp_lt_u32 s59, 196608
  s_cbranch_scc1 main_kernel_slow2
main_kernel_fast:
  v_lshrrev_b32 v18, 4, v9
  v_mul_u32_u24 v18, 20480, v18
  v_and_b32 v19, 15, v9
  v_lshlrev_b32 v19, 4, v19
  v_add_u32 v18, v18, v19
  v_lshrrev_b32 v14, 5, v2
  v_lshlrev_b32 v19, 8, v14
  v_add_u32 v19, v18, v19
  s_lshl_b32 s46, s41, 1
  s_add_u32 s46, s46, s42
  s_lshl_b32 s46, s46, 10
  s_lshr_b32 s47, s41, 1
  s_add_u32 s47, s47, 16
  s_lshl_b32 s47, s47, 10
  s_and_b32 s48, s41, 1
  s_lshl_b32 s48, s48, 1
  s_add_u32 s48, s48, s42
  s_lshl_b32 s48, s48, 8
  s_add_u32 s47, s47, s48
  v_cmp_eq_u32 vcc, 0, v14
  v_mov_b32 v20, 2130706432
  s_nop 0
  v_cndmask_b32 v18, v20, v18, vcc
  s_nop 4
  v_rcp_f32 v16, v44
  v_rcp_f32 v17, v60
  v_mul_f32 v16, v16, v12
  v_mul_f32 v17, v17, v12
  v_mul_f32 v32, v16, v32
  v_mul_f32 v33, v16, v33
  v_mul_f32 v34, v16, v34
  v_mul_f32 v35, v16, v35
  v_mul_f32 v36, v16, v36
  v_mul_f32 v37, v16, v37
  v_mul_f32 v38, v16, v38
  v_mul_f32 v39, v16, v39
  v_mul_f32 v40, v16, v40
  v_mul_f32 v41, v16, v41
  v_mul_f32 v42, v16, v42
  v_mul_f32 v43, v16, v43
  v_cvt_pk_bf16_f32 v64, v32, v33
  v_cvt_pk_bf16_f32 v65, v34, v35
  v_cvt_pk_bf16_f32 v66, v36, v37
  v_cvt_pk_bf16_f32 v67, v38, v39
  v_cvt_pk_bf16_f32 v72, v40, v41
  v_cvt_pk_bf16_f32 v73, v42, v43
  buffer_store_dwordx4 v[64:67], v19, s[24:27], s46 offen offset:0 sc1
  v_mul_f32 v48, v17, v48
  v_mul_f32 v49, v17, v49
  v_mul_f32 v50, v17, v50
  v_mul_f32 v51, v17, v51
  v_mul_f32 v52, v17, v52
  v_mul_f32 v53, v17, v53
  v_mul_f32 v54, v17, v54
  v_mul_f32 v55, v17, v55
  v_mul_f32 v56, v17, v56
  v_mul_f32 v57, v17, v57
  v_mul_f32 v58, v17, v58
  v_mul_f32 v59, v17, v59
  v_cvt_pk_bf16_f32 v68, v48, v49
  v_cvt_pk_bf16_f32 v69, v50, v51
  v_cvt_pk_bf16_f32 v70, v52, v53
  v_cvt_pk_bf16_f32 v71, v54, v55
  v_cvt_pk_bf16_f32 v74, v56, v57
  v_cvt_pk_bf16_f32 v75, v58, v59
  buffer_store_dwordx4 v[68:71], v19, s[24:27], s46 offen offset:512 sc1
  buffer_store_dwordx4 v[72:75], v18, s[24:27], s47 offen sc1
  s_waitcnt vmcnt(0)
  s_barrier
  s_cmp_lg_u32 s3, 0
  s_cbranch_scc1 main_kernel_pub6
  s_lshl_b32 s46, s40, 3
  s_add_u32 s46, s46, s41
  s_lshl_b32 s46, s46, 2
  s_add_u32 s46, s46, 2048
  v_mov_b32 v252, 0
  v_mov_b32 v253, 1
  s_mov_b64 s[34:35], exec
  s_mov_b64 exec, 1
  buffer_store_dword v253, v252, s[28:31], s46 offen sc1
  s_mov_b64 exec, s[34:35]
main_kernel_pub6:
  s_endpgm
main_kernel_B:
  s_sub_u32 s46, s2, 256
  s_and_b32 s47, s46, 7
  s_lshr_b32 s46, s46, 3
  s_lshr_b32 s40, s46, 3
  s_lshl_b32 s47, s47, 2
  s_add_u32 s40, s40, s47
  s_and_b32 s41, s46, 7
  s_waitcnt lgkmcnt(0)
  s_add_u32 s28, s4, 28344320
  s_addc_u32 s29, s5, 0
  s_mov_b32 s30, 4096
  s_mov_b32 s31, 0x20000
  v_cmp_gt_u32 s[38:39], 32, v2
  s_mul_i32 s45, s41, 5
  s_lshl_b32 s70, s40, 2
  s_add_u32 s70, s70, s3
  s_add_u32 s52, s4, 1638400
  s_addc_u32 s53, s5, 0
  s_mov_b32 s54, 819200
  s_mov_b32 s55, 0x20000
  s_mul_i32 s46, s45, 20480
  v_add_u32 v10, s46, v3
  v_add_u32 v11, 20480, v10
  v_add_u32 v12, 40960, v10
  v_add_u32 v13, 61440, v10
  v_add_u32 v14, 81920, v10
  s_lshl_b32 s58, s3, 10
  s_add_u32 s48, s4, 10403840
  s_addc_u32 s49, s5, 0
  s_mov_b32 s50, 2621440
  s_mov_b32 s51, 0x20000
  s_add_u32 s46, s3, 0
  s_and_b32 s46, s46, 3
  s_lshl_b32 s47, s40, 2
  s_add_u32 s46, s46, s47
  s_mul_i32 s46, s46, 20480
  v_add_u32 v6, s46, v3
  s_add_u32 s46, s3, 1
  s_and_b32 s46, s46, 3
  s_lshl_b32 s47, s40, 2
  s_add_u32 s46, s46, s47
  s_mul_i32 s46, s46, 20480
  v_add_u32 v7, s46, v3
  s_add_u32 s46, s3, 2
  s_and_b32 s46, s46, 3
  s_lshl_b32 s47, s40, 2
  s_add_u32 s46, s46, s47
  s_mul_i32 s46, s46, 20480
  v_add_u32 v8, s46, v3
  s_add_u32 s46, s3, 3
  s_and_b32 s46, s46, 3
  s_lshl_b32 s47, s40, 2
  s_add_u32 s46, s46, s47
  s_mul_i32 s46, s46, 20480
  v_add_u32 v9, s46, v3
  s_add_u32 s59, s58, 0
  buffer_load_dwordx4 v[112:115], v10, s[52:55], s59 offen
  buffer_load_dwordx4 v[116:119], v11, s[52:55], s59 offen
  buffer_load_dwordx4 v[120:123], v12, s[52:55], s59 offen
  buffer_load_dwordx4 v[124:127], v13, s[52:55], s59 offen
  buffer_load_dwordx4 v[128:131], v14, s[52:55], s59 offen
  buffer_load_dwordx4 v[96:99], v6, s[48:51], s59 offen
  buffer_load_dwordx4 v[100:103], v7, s[48:51], s59 offen
  buffer_load_dwordx4 v[104:107], v8, s[48:51], s59 offen
  buffer_load_dwordx4 v[108:111], v9, s[48:51], s59 offen
  s_add_u32 s59, s58, 4096
  buffer_load_dwordx4 v[148:151], v10, s[52:55], s59 offen
  buffer_load_dwordx4 v[152:155], v11, s[52:55], s59 offen
  buffer_load_dwordx4 v[156:159], v12, s[52:55], s59 offen
  buffer_load_dwordx4 v[160:163], v13, s[52:55], s59 offen
  buffer_load_dwordx4 v[164:167], v14, s[52:55], s59 offen
  buffer_load_dwordx4 v[132:135], v6, s[48:51], s59 offen
  buffer_load_dwordx4 v[136:139], v7, s[48:51], s59 offen
  buffer_load_dwordx4 v[140:143], v8, s[48:51], s59 offen
  buffer_load_dwordx4 v[144:147], v9, s[48:51], s59 offen
  s_add_u32 s59, s58, 8192
  buffer_load_dwordx4 v[184:187], v10, s[52:55], s59 offen
  buffer_load_dwordx4 v[188:191], v11, s[52:55], s59 offen
  buffer_load_dwordx4 v[192:195], v12, s[52:55], s59 offen
  buffer_load_dwordx4 v[196:199], v13, s[52:55], s59 offen
  buffer_load_dwordx4 v[200:203], v14, s[52:55], s59 offen
  buffer_load_dwordx4 v[168:171], v6, s[48:51], s59 offen
  buffer_load_dwordx4 v[172:175], v7, s[48:51], s59 offen
  buffer_load_dwordx4 v[176:179], v8, s[48:51], s59 offen
  buffer_load_dwordx4 v[180:183], v9, s[48:51], s59 offen
  s_add_u32 s84, s4, 28180480
  s_addc_u32 s85, s5, 0
  s_mov_b32 s86, 8192
  s_mov_b32 s87, 0x20000
  s_lshl_b32 s47, s70, 4
  v_and_b32 v5, 15, v2
  v_add_u32 v5, s47, v5
  v_lshlrev_b32 v4, 2, v5
  s_mov_b32 s76, s32
  s_mov_b32 s77, s33
  s_mov_b32 s78, 2621440
  s_mov_b32 s79, 0x20000
  v_mul_u32_u24 v5, 1280, v5
  v_lshrrev_b32 v15, 4, v2
  v_lshlrev_b32 v15, 3, v15
  v_add_u32 v5, v5, v15
  s_mul_i32 s89, s41, 160
  buffer_load_dwordx2 v[240:241], v5, s[76:79], s89 offen offset:0
  buffer_load_dwordx2 v[242:243], v5, s[76:79], s89 offen offset:32
  buffer_load_dwordx2 v[244:245], v5, s[76:79], s89 offen offset:64
  buffer_load_dwordx2 v[246:247], v5, s[76:79], s89 offen offset:96
  buffer_load_dwordx2 v[248:249], v5, s[76:79], s89 offen offset:128
  buffer_load_dword v250, v4, s[84:87], 0 offen
  s_waitcnt vmcnt(24)
  s_add_u32 s59, s58, 12288
  v_mfma_f32_16x16x32_bf16 v[16:19], v[112:115], v[96:99], 0
  v_mfma_f32_16x16x32_bf16 v[36:39], v[112:115], v[100:103], 0
  v_mfma_f32_16x16x32_bf16 v[56:59], v[112:115], v[104:107], 0
  v_mfma_f32_16x16x32_bf16 v[76:79], v[112:115], v[108:111], 0
  buffer_load_dwordx4 v[112:115], v10, s[52:55], s59 offen
  v_mfma_f32_16x16x32_bf16 v[20:23], v[116:119], v[96:99], 0
  v_mfma_f32_16x16x32_bf16 v[40:43], v[116:119], v[100:103], 0
  v_mfma_f32_16x16x32_bf16 v[60:63], v[116:119], v[104:107], 0
  v_mfma_f32_16x16x32_bf16 v[80:83], v[116:119], v[108:111], 0
  buffer_load_dwordx4 v[116:119], v11, s[52:55], s59 offen
  v_mfma_f32_16x16x32_bf16 v[24:27], v[120:123], v[96:99], 0
  v_mfma_f32_16x16x32_bf16 v[44:47], v[120:123], v[100:103], 0
  v_mfma_f32_16x16x32_bf16 v[64:67], v[120:123], v[104:107], 0
  v_mfma_f32_16x16x32_bf16 v[84:87], v[120:123], v[108:111], 0
  buffer_load_dwordx4 v[120:123], v12, s[52:55], s59 offen
  v_mfma_f32_16x16x32_bf16 v[28:31], v[124:127], v[96:99], 0
  v_mfma_f32_16x16x32_bf16 v[48:51], v[124:127], v[100:103], 0
  v_mfma_f32_16x16x32_bf16 v[68:71], v[124:127], v[104:107], 0
  v_mfma_f32_16x16x32_bf16 v[88:91], v[124:127], v[108:111], 0
  buffer_load_dwordx4 v[124:127], v13, s[52:55], s59 offen
  v_mfma_f32_16x16x32_bf16 v[32:35], v[128:131], v[96:99], 0
  v_mfma_f32_16x16x32_bf16 v[52:55], v[128:131], v[100:103], 0
  v_mfma_f32_16x16x32_bf16 v[72:75], v[128:131], v[104:107], 0
  v_mfma_f32_16x16x32_bf16 v[92:95], v[128:131], v[108:111], 0
  buffer_load_dwordx4 v[128:131], v14, s[52:55], s59 offen
  buffer_load_dwordx4 v[96:99], v6, s[48:51], s59 offen
  buffer_load_dwordx4 v[100:103], v7, s[48:51], s59 offen
  buffer_load_dwordx4 v[104:107], v8, s[48:51], s59 offen
  buffer_load_dwordx4 v[108:111], v9, s[48:51], s59 offen
  s_waitcnt vmcnt(24)
  s_add_u32 s59, s58, 16384
  v_mfma_f32_16x16x32_bf16 v[16:19], v[148:151], v[132:135], v[16:19]
  v_mfma_f32_16x16x32_bf16 v[36:39], v[148:151], v[136:139], v[36:39]
  v_mfma_f32_16x16x32_bf16 v[56:59], v[148:151], v[140:143], v[56:59]
  v_mfma_f32_16x16x32_bf16 v[76:79], v[148:151], v[144:147], v[76:79]
  buffer_load_dwordx4 v[148:151], v10, s[52:55], s59 offen
  v_mfma_f32_16x16x32_bf16 v[20:23], v[152:155], v[132:135], v[20:23]
  v_mfma_f32_16x16x32_bf16 v[40:43], v[152:155], v[136:139], v[40:43]
  v_mfma_f32_16x16x32_bf16 v[60:63], v[152:155], v[140:143], v[60:63]
  v_mfma_f32_16x16x32_bf16 v[80:83], v[152:155], v[144:147], v[80:83]
  buffer_load_dwordx4 v[152:155], v11, s[52:55], s59 offen
  v_mfma_f32_16x16x32_bf16 v[24:27], v[156:159], v[132:135], v[24:27]
  v_mfma_f32_16x16x32_bf16 v[44:47], v[156:159], v[136:139], v[44:47]
  v_mfma_f32_16x16x32_bf16 v[64:67], v[156:159], v[140:143], v[64:67]
  v_mfma_f32_16x16x32_bf16 v[84:87], v[156:159], v[144:147], v[84:87]
  buffer_load_dwordx4 v[156:159], v12, s[52:55], s59 offen
  v_mfma_f32_16x16x32_bf16 v[28:31], v[160:163], v[132:135], v[28:31]
  v_mfma_f32_16x16x32_bf16 v[48:51], v[160:163], v[136:139], v[48:51]
  v_mfma_f32_16x16x32_bf16 v[68:71], v[160:163], v[140:143], v[68:71]
  v_mfma_f32_16x16x32_bf16 v[88:91], v[160:163], v[144:147], v[88:91]
  buffer_load_dwordx4 v[160:163], v13, s[52:55], s59 offen
  v_mfma_f32_16x16x32_bf16 v[32:35], v[164:167], v[132:135], v[32:35]
  v_mfma_f32_16x16x32_bf16 v[52:55], v[164:167], v[136:139], v[52:55]
  v_mfma_f32_16x16x32_bf16 v[72:75], v[164:167], v[140:143], v[72:75]
  v_mfma_f32_16x16x32_bf16 v[92:95], v[164:167], v[144:147], v[92:95]
  buffer_load_dwordx4 v[164:167], v14, s[52:55], s59 offen
  buffer_load_dwordx4 v[132:135], v6, s[48:51], s59 offen
  buffer_load_dwordx4 v[136:139], v7, s[48:51], s59 offen
  buffer_load_dwordx4 v[140:143], v8, s[48:51], s59 offen
  buffer_load_dwordx4 v[144:147], v9, s[48:51], s59 offen
  s_waitcnt vmcnt(24)
  v_mfma_f32_16x16x32_bf16 v[16:19], v[184:187], v[168:171], v[16:19]
  v_mfma_f32_16x16x32_bf16 v[36:39], v[184:187], v[172:175], v[36:39]
  v_mfma_f32_16x16x32_bf16 v[56:59], v[184:187], v[176:179], v[56:59]
  v_mfma_f32_16x16x32_bf16 v[76:79], v[184:187], v[180:183], v[76:79]
  v_mfma_f32_16x16x32_bf16 v[20:23], v[188:191], v[168:171], v[20:23]
  v_mfma_f32_16x16x32_bf16 v[40:43], v[188:191], v[172:175], v[40:43]
  v_mfma_f32_16x16x32_bf16 v[60:63], v[188:191], v[176:179], v[60:63]
  v_mfma_f32_16x16x32_bf16 v[80:83], v[188:191], v[180:183], v[80:83]
  v_mfma_f32_16x16x32_bf16 v[24:27], v[192:195], v[168:171], v[24:27]
  v_mfma_f32_16x16x32_bf16 v[44:47], v[192:195], v[172:175], v[44:47]
  v_mfma_f32_16x16x32_bf16 v[64:67], v[192:195], v[176:179], v[64:67]
  v_mfma_f32_16x16x32_bf16 v[84:87], v[192:195], v[180:183], v[84:87]
  v_mfma_f32_16x16x32_bf16 v[28:31], v[196:199], v[168:171], v[28:31]
  v_mfma_f32_16x16x32_bf16 v[48:51], v[196:199], v[172:175], v[48:51]
  v_mfma_f32_16x16x32_bf16 v[68:71], v[196:199], v[176:179], v[68:71]
  v_mfma_f32_16x16x32_bf16 v[88:91], v[196:199], v[180:183], v[88:91]
  v_mfma_f32_16x16x32_bf16 v[32:35], v[200:203], v[168:171], v[32:35]
  v_mfma_f32_16x16x32_bf16 v[52:55], v[200:203], v[172:175], v[52:55]
  v_mfma_f32_16x16x32_bf16 v[72:75], v[200:203], v[176:179], v[72:75]
  v_mfma_f32_16x16x32_bf16 v[92:95], v[200:203], v[180:183], v[92:95]
  s_waitcnt vmcnt(9)
  v_mfma_f32_16x16x32_bf16 v[16:19], v[112:115], v[96:99], v[16:19]
  v_mfma_f32_16x16x32_bf16 v[36:39], v[112:115], v[100:103], v[36:39]
  v_mfma_f32_16x16x32_bf16 v[56:59], v[112:115], v[104:107], v[56:59]
  v_mfma_f32_16x16x32_bf16 v[76:79], v[112:115], v[108:111], v[76:79]
  v_mfma_f32_16x16x32_bf16 v[20:23], v[116:119], v[96:99], v[20:23]
  v_mfma_f32_16x16x32_bf16 v[40:43], v[116:119], v[100:103], v[40:43]
  v_mfma_f32_16x16x32_bf16 v[60:63], v[116:119], v[104:107], v[60:63]
  v_mfma_f32_16x16x32_bf16 v[80:83], v[116:119], v[108:111], v[80:83]
  v_mfma_f32_16x16x32_bf16 v[24:27], v[120:123], v[96:99], v[24:27]
  v_mfma_f32_16x16x32_bf16 v[44:47], v[120:123], v[100:103], v[44:47]
  v_mfma_f32_16x16x32_bf16 v[64:67], v[120:123], v[104:107], v[64:67]
  v_mfma_f32_16x16x32_bf16 v[84:87], v[120:123], v[108:111], v[84:87]
  v_mfma_f32_16x16x32_bf16 v[28:31], v[124:127], v[96:99], v[28:31]
  v_mfma_f32_16x16x32_bf16 v[48:51], v[124:127], v[100:103], v[48:51]
  v_mfma_f32_16x16x32_bf16 v[68:71], v[124:127], v[104:107], v[68:71]
  v_mfma_f32_16x16x32_bf16 v[88:91], v[124:127], v[108:111], v[88:91]
  v_mfma_f32_16x16x32_bf16 v[32:35], v[128:131], v[96:99], v[32:35]
  v_mfma_f32_16x16x32_bf16 v[52:55], v[128:131], v[100:103], v[52:55]
  v_mfma_f32_16x16x32_bf16 v[72:75], v[128:131], v[104:107], v[72:75]
  v_mfma_f32_16x16x32_bf16 v[92:95], v[128:131], v[108:111], v[92:95]
  s_waitcnt vmcnt(0)
  v_mfma_f32_16x16x32_bf16 v[16:19], v[148:151], v[132:135], v[16:19]
  v_mfma_f32_16x16x32_bf16 v[36:39], v[148:151], v[136:139], v[36:39]
  v_mfma_f32_16x16x32_bf16 v[56:59], v[148:151], v[140:143], v[56:59]
  v_mfma_f32_16x16x32_bf16 v[76:79], v[148:151], v[144:147], v[76:79]
  v_mfma_f32_16x16x32_bf16 v[20:23], v[152:155], v[132:135], v[20:23]
  v_mfma_f32_16x16x32_bf16 v[40:43], v[152:155], v[136:139], v[40:43]
  v_mfma_f32_16x16x32_bf16 v[60:63], v[152:155], v[140:143], v[60:63]
  v_mfma_f32_16x16x32_bf16 v[80:83], v[152:155], v[144:147], v[80:83]
  v_mfma_f32_16x16x32_bf16 v[24:27], v[156:159], v[132:135], v[24:27]
  v_mfma_f32_16x16x32_bf16 v[44:47], v[156:159], v[136:139], v[44:47]
  v_mfma_f32_16x16x32_bf16 v[64:67], v[156:159], v[140:143], v[64:67]
  v_mfma_f32_16x16x32_bf16 v[84:87], v[156:159], v[144:147], v[84:87]
  v_mfma_f32_16x16x32_bf16 v[28:31], v[160:163], v[132:135], v[28:31]
  v_mfma_f32_16x16x32_bf16 v[48:51], v[160:163], v[136:139], v[48:51]
  v_mfma_f32_16x16x32_bf16 v[68:71], v[160:163], v[140:143], v[68:71]
  v_mfma_f32_16x16x32_bf16 v[88:91], v[160:163], v[144:147], v[88:91]
  v_mfma_f32_16x16x32_bf16 v[32:35], v[164:167], v[132:135], v[32:35]
  v_mfma_f32_16x16x32_bf16 v[52:55], v[164:167], v[136:139], v[52:55]
  v_mfma_f32_16x16x32_bf16 v[72:75], v[164:167], v[140:143], v[72:75]
  v_mfma_f32_16x16x32_bf16 v[92:95], v[164:167], v[144:147], v[92:95]
  s_setprio 2
  s_setprio 0
  s_sub_u32 s46, s41, 6
  s_max_i32 s95, s46, 0
  s_mul_i32 s92, s41, 14
  s_lshl_b32 s46, s95, 1
  s_sub_u32 s92, s92, s46
  s_lshl_b32 s46, s3, 2
  s_cmp_eq_u32 s3, 3
  s_cselect_b32 s46, 11, s46
  s_mul_i32 s47, s3, 3
  s_cmp_ge_u32 s41, 6
  s_cselect_b32 s46, s47, s46
  s_add_u32 s45, s92, s46
  s_cmp_lt_u32 s3, 2
  s_cselect_b32 s93, 4, 3
  s_cmp_ge_u32 s41, 6
  s_cselect_b32 s93, 3, s93
  s_add_u32 s52, s4, 3276800
  s_addc_u32 s53, s5, 0
  s_mov_b32 s54, 2211840
  s_mov_b32 s55, 0x20000
  s_mul_i32 s46, s45, 20480
  v_add_u32 v10, s46, v3
  v_add_u32 v11, 20480, v10
  v_add_u32 v12, 40960, v10
  v_add_u32 v13, 61440, v10
  s_cmp_eq_u32 s93, 4
  s_cselect_b64 vcc, -1, 0
  v_mov_b32 v9, 2130706432
  v_cndmask_b32 v13, v9, v13, vcc
  s_setprio 2
  s_add_u32 s46, s3, 1
  s_and_b32 s46, s46, 3
  s_mul_i32 s46, s46, 15360
  s_add_u32 s46, s46, 0
  v_add_u32 v4, s46, v3
  ds_write_b128 v4, v[36:39] offset:0
  ds_write_b128 v4, v[40:43] offset:1024
  ds_write_b128 v4, v[44:47] offset:2048
  ds_write_b128 v4, v[48:51] offset:3072
  ds_write_b128 v4, v[52:55] offset:4096
  s_add_u32 s46, s3, 2
  s_and_b32 s46, s46, 3
  s_mul_i32 s46, s46, 15360
  s_add_u32 s46, s46, 5120
  v_add_u32 v4, s46, v3
  ds_write_b128 v4, v[56:59] offset:0
  ds_write_b128 v4, v[60:63] offset:1024
  ds_write_b128 v4, v[64:67] offset:2048
  ds_write_b128 v4, v[68:71] offset:3072
  ds_write_b128 v4, v[72:75] offset:4096
  s_add_u32 s46, s3, 3
  s_and_b32 s46, s46, 3
  s_mul_i32 s46, s46, 15360
  s_add_u32 s46, s46, 10240
  v_add_u32 v4, s46, v3
  ds_write_b128 v4, v[76:79] offset:0
  ds_write_b128 v4, v[80:83] offset:1024
  ds_write_b128 v4, v[84:87] offset:2048
  ds_write_b128 v4, v[88:91] offset:3072
  ds_write_b128 v4, v[92:95] offset:4096
  s_add_u32 s72, s4, 13025280
  s_addc_u32 s73, s5, 0
  s_mov_b32 s74, 2621440
  s_mov_b32 s75, 0x20000
  s_add_u32 s80, s4, 28209152
  s_addc_u32 s81, s5, 0
  s_mov_b32 s82, 131072
  s_mov_b32 s83, 0x20000
  s_mul_i32 s71, s70, 20480
  v_add_u32 v6, s71, v3
  v_mov_b32 v7, 2130706432
  v_cndmask_b32 v7, v7, v6, s[38:39]
  v_sub_f32 v250, 1.0, v250
  v_lshlrev_b32 v192, 16, v240
  v_and_b32 v193, 0xffff0000, v240
  v_lshlrev_b32 v194, 16, v241
  v_and_b32 v195, 0xffff0000, v241
  v_lshlrev_b32 v196, 16, v242
  v_and_b32 v197, 0xffff0000, v242
  v_lshlrev_b32 v198, 16, v243
  v_and_b32 v199, 0xffff0000, v243
  v_lshlrev_b32 v200, 16, v244
  v_and_b32 v201, 0xffff0000, v244
  v_lshlrev_b32 v202, 16, v245
  v_and_b32 v203, 0xffff0000, v245
  v_lshlrev_b32 v204, 16, v246
  v_and_b32 v205, 0xffff0000, v246
  v_lshlrev_b32 v206, 16, v247
  v_and_b32 v207, 0xffff0000, v247
  v_lshlrev_b32 v208, 16, v248
  v_and_b32 v209, 0xffff0000, v248
  v_lshlrev_b32 v210, 16, v249
  v_and_b32 v211, 0xffff0000, v249
  s_lshl_b32 s47, s70, 4
  v_and_b32 v14, 15, v2
  v_add_u32 v14, s47, v14
  v_lshlrev_b32 v14, 6, v14
  s_lshl_b32 s89, s41, 3
  v_cmp_gt_u32 vcc, 16, v2
  v_mov_b32 v9, 2130706432
  s_nop 0
  v_cndmask_b32 v14, v9, v14, vcc
  s_mul_i32 s46, s3, 15360
  v_add_u32 v5, s46, v3
  s_waitcnt lgkmcnt(0)
  s_barrier
  ds_read_b128 v[36:39], v5 offset:0
  ds_read_b128 v[40:43], v5 offset:1024
  ds_read_b128 v[44:47], v5 offset:2048
  ds_read_b128 v[48:51], v5 offset:3072
  ds_read_b128 v[52:55], v5 offset:4096
  ds_read_b128 v[56:59], v5 offset:5120
  ds_read_b128 v[60:63], v5 offset:6144
  ds_read_b128 v[64:67], v5 offset:7168
  ds_read_b128 v[68:71], v5 offset:8192
  ds_read_b128 v[72:75], v5 offset:9216
  ds_read_b128 v[76:79], v5 offset:10240
  ds_read_b128 v[80:83], v5 offset:11264
  ds_read_b128 v[84:87], v5 offset:12288
  ds_read_b128 v[88:91], v5 offset:13312
  ds_read_b128 v[92:95], v5 offset:14336
  s_waitcnt lgkmcnt(10)
  v_pk_add_f32 v[16:17], v[16:17], v[36:37]
  v_pk_add_f32 v[18:19], v[18:19], v[38:39]
  v_pk_add_f32 v[20:21], v[20:21], v[40:41]
  v_pk_add_f32 v[22:23], v[22:23], v[42:43]
  v_pk_add_f32 v[24:25], v[24:25], v[44:45]
  v_pk_add_f32 v[26:27], v[26:27], v[46:47]
  v_pk_add_f32 v[28:29], v[28:29], v[48:49]
  v_pk_add_f32 v[30:31], v[30:31], v[50:51]
  v_pk_add_f32 v[32:33], v[32:33], v[52:53]
  v_pk_add_f32 v[34:35], v[34:35], v[54:55]
  s_waitcnt lgkmcnt(5)
  v_pk_add_f32 v[16:17], v[16:17], v[56:57]
  v_pk_add_f32 v[18:19], v[18:19], v[58:59]
  v_pk_add_f32 v[20:21], v[20:21], v[60:61]
  v_pk_add_f32 v[22:23], v[22:23], v[62:63]
  v_pk_add_f32 v[24:25], v[24:25], v[64:65]
  v_pk_add_f32 v[26:27], v[26:27], v[66:67]
  v_pk_add_f32 v[28:29], v[28:29], v[68:69]
  v_pk_add_f32 v[30:31], v[30:31], v[70:71]
  v_pk_add_f32 v[32:33], v[32:33], v[72:73]
  v_pk_add_f32 v[34:35], v[34:35], v[74:75]
  s_waitcnt lgkmcnt(0)
  v_pk_add_f32 v[16:17], v[16:17], v[76:77]
  v_pk_add_f32 v[18:19], v[18:19], v[78:79]
  v_pk_add_f32 v[20:21], v[20:21], v[80:81]
  v_pk_add_f32 v[22:23], v[22:23], v[82:83]
  v_pk_add_f32 v[24:25], v[24:25], v[84:85]
  v_pk_add_f32 v[26:27], v[26:27], v[86:87]
  v_pk_add_f32 v[28:29], v[28:29], v[88:89]
  v_pk_add_f32 v[30:31], v[30:31], v[90:91]
  v_pk_add_f32 v[32:33], v[32:33], v[92:93]
  v_pk_add_f32 v[34:35], v[34:35], v[94:95]
  v_pk_add_f32 v[16:17], v[16:17], v[192:193]
  v_pk_add_f32 v[18:19], v[18:19], v[194:195]
  v_pk_add_f32 v[20:21], v[20:21], v[196:197]
  v_pk_add_f32 v[22:23], v[22:23], v[198:199]
  v_pk_add_f32 v[24:25], v[24:25], v[200:201]
  v_pk_add_f32 v[26:27], v[26:27], v[202:203]
  v_pk_add_f32 v[28:29], v[28:29], v[204:205]
  v_pk_add_f32 v[30:31], v[30:31], v[206:207]
  v_pk_add_f32 v[32:33], v[32:33], v[208:209]
  v_pk_add_f32 v[34:35], v[34:35], v[210:211]
  v_cvt_pk_bf16_f32 v240, v16, v17
  v_cvt_pk_bf16_f32 v241, v18, v19
  v_cvt_pk_bf16_f32 v242, v20, v21
  v_cvt_pk_bf16_f32 v243, v22, v23
  v_cvt_pk_bf16_f32 v244, v24, v25
  v_cvt_pk_bf16_f32 v245, v26, v27
  v_cvt_pk_bf16_f32 v246, v28, v29
  v_cvt_pk_bf16_f32 v247, v30, v31
  v_cvt_pk_bf16_f32 v248, v32, v33
  v_cvt_pk_bf16_f32 v249, v34, v35
  s_lshr_b32 s46, s41, 1
  s_mul_i32 s46, s46, 5
  s_and_b32 s47, s41, 1
  s_lshl_b32 s36, s47, 1
  s_add_u32 s36, s36, s46
  s_lshl_b32 s36, s36, 10
  s_add_u32 s37, s46, 4
  s_lshl_b32 s37, s37, 10
  s_lshl_b32 s47, s47, 9
  s_add_u32 s37, s37, s47
  buffer_store_dwordx4 v[240:243], v6, s[72:75], s36 offen sc1
  buffer_store_dwordx4 v[244:247], v6, s[72:75], s36 offen offset:1024 sc1
  v_mov_b32 v212, v248
  v_mov_b32 v213, v249
  v_mov_b32 v214, v248
  v_mov_b32 v215, v249
  s_nop 0
  v_permlane32_swap_b32 v212, v214
  v_permlane32_swap_b32 v213, v215
  buffer_store_dwordx4 v[212:215], v7, s[72:75], s37 offen sc1
  s_mov_b32 s71, 0x3f803f80
  v_dot2_f32_bf16 v216, v240, s71, 0
  v_dot2_f32_bf16 v217, v240, v240, 0
  v_dot2_f32_bf16 v216, v241, s71, v216
  v_dot2_f32_bf16 v217, v241, v241, v217
  v_dot2_f32_bf16 v216, v242, s71, v216
  v_dot2_f32_bf16 v217, v242, v242, v217
  v_dot2_f32_bf16 v216, v243, s71, v216
  v_dot2_f32_bf16 v217, v243, v243, v217
  v_dot2_f32_bf16 v216, v244, s71, v216
  v_dot2_f32_bf16 v217, v244, v244, v217
  v_dot2_f32_bf16 v216, v245, s71, v216
  v_dot2_f32_bf16 v217, v245, v245, v217
  v_dot2_f32_bf16 v216, v246, s71, v216
  v_dot2_f32_bf16 v217, v246, v246, v217
  v_dot2_f32_bf16 v216, v247, s71, v216
  v_dot2_f32_bf16 v217, v247, v247, v217
  v_dot2_f32_bf16 v216, v248, s71, v216
  v_dot2_f32_bf16 v217, v248, v248, v217
  v_dot2_f32_bf16 v216, v249, s71, v216
  v_dot2_f32_bf16 v217, v249, v249, v217
  s_nop 1
  v_mov_b32 v218, v216
  s_nop 1
  v_permlane16_swap_b32 v216, v218
  v_add_f32 v216, v216, v218
  v_mov_b32 v218, v216
  s_nop 1
  v_permlane32_swap_b32 v216, v218
  v_add_f32 v216, v216, v218
  v_mov_b32 v219, v217
  s_nop 1
  v_permlane16_swap_b32 v217, v219
  v_add_f32 v217, v217, v219
  v_mov_b32 v219, v217
  s_nop 1
  v_permlane32_swap_b32 v217, v219
  v_add_f32 v217, v217, v219
  buffer_store_dwordx2 v[216:217], v14, s[80:83], s89 offen sc1
  s_setprio 0
  s_waitcnt vmcnt(0)
  s_barrier
  s_cmp_lg_u32 s3, 0
  s_cbranch_scc1 main_kernel_pub7
  s_lshl_b32 s46, s40, 3
  s_add_u32 s46, s46, s41
  s_lshl_b32 s46, s46, 2
  s_add_u32 s46, s46, 0
  v_mov_b32 v252, 0
  v_mov_b32 v253, 1
  s_mov_b64 s[34:35], exec
  s_mov_b64 exec, 1
  buffer_store_dword v253, v252, s[28:31], s46 offen sc1
  s_mov_b64 exec, s[34:35]
main_kernel_pub7:
  s_add_u32 s80, s4, 28348416
  s_addc_u32 s81, s5, 0
  s_mov_b32 s82, 138240
  s_mov_b32 s83, 0x20000
  v_lshlrev_b32 v4, 2, v2
  s_lshl_b32 s89, s45, 6
  buffer_load_dword v220, v4, s[80:83], s89 offen
  s_add_u32 s89, s89, 6912
  buffer_load_dword v221, v4, s[80:83], s89 offen
  s_add_u32 s89, s89, 6912
  buffer_load_dword v222, v4, s[80:83], s89 offen
  s_add_u32 s89, s89, 6912
  buffer_load_dword v223, v4, s[80:83], s89 offen
  s_add_u32 s89, s89, 6912
  buffer_load_dword v224, v4, s[80:83], s89 offen
  s_add_u32 s89, s89, 6912
  buffer_load_dword v225, v4, s[80:83], s89 offen
  s_add_u32 s89, s89, 6912
  buffer_load_dword v226, v4, s[80:83], s89 offen
  s_add_u32 s89, s89, 6912
  buffer_load_dword v227, v4, s[80:83], s89 offen
  s_add_u32 s89, s89, 6912
  buffer_load_dword v228, v4, s[80:83], s89 offen
  s_add_u32 s89, s89, 6912
  buffer_load_dword v229, v4, s[80:83], s89 offen
  s_add_u32 s89, s89, 6912
  buffer_load_dword v230, v4, s[80:83], s89 offen
  s_add_u32 s89, s89, 6912
  buffer_load_dword v231, v4, s[80:83], s89 offen
  s_add_u32 s89, s89, 6912
  buffer_load_dword v232, v4, s[80:83], s89 offen
  s_add_u32 s89, s89, 6912
  buffer_load_dword v233, v4, s[80:83], s89 offen
  s_add_u32 s89, s89, 6912
  buffer_load_dword v234, v4, s[80:83], s89 offen
  s_add_u32 s89, s89, 6912
  buffer_load_dword v235, v4, s[80:83], s89 offen
  s_add_u32 s89, s89, 6912
  buffer_load_dword v236, v4, s[80:83], s89 offen
  s_add_u32 s89, s89, 6912
  buffer_load_dword v237, v4, s[80:83], s89 offen
  s_add_u32 s89, s89, 6912
  buffer_load_dword v238, v4, s[80:83], s89 offen
  s_add_u32 s89, s89, 6912
  buffer_load_dword v239, v4, s[80:83], s89 offen
  s_add_u32 s89, s89, 6912
  s_mov_b32 s59, 0
  buffer_load_dwordx4 v[96:99], v10, s[52:55], s59 offen
  buffer_load_dwordx4 v[100:103], v11, s[52:55], s59 offen
  buffer_load_dwordx4 v[104:107], v12, s[52:55], s59 offen
  buffer_load_dwordx4 v[108:111], v13, s[52:55], s59 offen
  s_mov_b32 s59, 1024
  buffer_load_dwordx4 v[112:115], v10, s[52:55], s59 offen
  buffer_load_dwordx4 v[116:119], v11, s[52:55], s59 offen
  buffer_load_dwordx4 v[120:123], v12, s[52:55], s59 offen
  buffer_load_dwordx4 v[124:127], v13, s[52:55], s59 offen
  s_mov_b32 s59, 2048
  buffer_load_dwordx4 v[128:131], v10, s[52:55], s59 offen
  buffer_load_dwordx4 v[132:135], v11, s[52:55], s59 offen
  buffer_load_dwordx4 v[136:139], v12, s[52:55], s59 offen
  buffer_load_dwordx4 v[140:143], v13, s[52:55], s59 offen
  s_mov_b32 s59, 3072
  buffer_load_dwordx4 v[144:147], v10, s[52:55], s59 offen
  buffer_load_dwordx4 v[148:151], v11, s[52:55], s59 offen
  buffer_load_dwordx4 v[152:155], v12, s[52:55], s59 offen
  buffer_load_dwordx4 v[156:159], v13, s[52:55], s59 offen
  s_mov_b32 s59, 4096
  buffer_load_dwordx4 v[160:163], v10, s[52:55], s59 offen
  buffer_load_dwordx4 v[164:167], v11, s[52:55], s59 offen
  buffer_load_dwordx4 v[168:171], v12, s[52:55], s59 offen
  buffer_load_dwordx4 v[172:175], v13, s[52:55], s59 offen
  s_mov_b32 s59, 5120
  buffer_load_dwordx4 v[176:179], v10, s[52:55], s59 offen
  buffer_load_dwordx4 v[180:183], v11, s[52:55], s59 offen
  buffer_load_dwordx4 v[184:187], v12, s[52:55], s59 offen
  buffer_load_dwordx4 v[188:191], v13, s[52:55], s59 offen
  s_lshl_b32 s46, s40, 5
  s_add_u32 s46, s46, 0
  v_and_b32 v4, 7, v2
  v_lshlrev_b32 v4, 2, v4
  s_mov_b32 s47, 400000
main_kernel_poll8:
  buffer_load_dword v253, v4, s[28:31], s46 offen sc1
  s_waitcnt vmcnt(0)
  v_cmp_ne_u32 vcc, 1, v253
  s_cmp_eq_u64 vcc, 0
  s_cbranch_scc1 main_kernel_pdone9
  s_sub_u32 s47, s47, 1
  s_cmp_lg_u32 s47, 0
  s_cbranch_scc1 main_kernel_poll8
main_kernel_pdone9:
  s_add_u32 s48, s4, 13025280
  s_addc_u32 s49, s5, 0
  s_mov_b32 s50, 2621440
  s_mov_b32 s51, 0x20000
  s_add_u32 s76, s4, 28209152
  s_addc_u32 s77, s5, 0
  s_mov_b32 s78, 131072
  s_mov_b32 s79, 0x20000
  s_add_u32 s84, s4, 28180480
  s_addc_u32 s85, s5, 0
  s_mov_b32 s86, 8192
  s_mov_b32 s87, 0x20000
  s_mul_i32 s59, s70, 20480
  buffer_load_dwordx4 v[16:19], v3, s[48:51], s59 offen offset:0 sc1
  buffer_load_dwordx4 v[20:23], v3, s[48:51], s59 offen offset:1024 sc1
  buffer_load_dwordx4 v[24:27], v3, s[48:51], s59 offen offset:2048 sc1
  buffer_load_dwordx4 v[28:31], v3, s[48:51], s59 offen offset:3072 sc1
  s_mul_i32 s59, s70, 20480
  s_add_u32 s59, s59, 4096
  buffer_load_dwordx4 v[32:35], v3, s[48:51], s59 offen offset:0 sc1
  buffer_load_dwordx4 v[36:39], v3, s[48:51], s59 offen offset:1024 sc1
  buffer_load_dwordx4 v[40:43], v3, s[48:51], s59 offen offset:2048 sc1
  buffer_load_dwordx4 v[44:47], v3, s[48:51], s59 offen offset:3072 sc1
  s_mul_i32 s59, s70, 20480
  s_add_u32 s59, s59, 8192
  buffer_load_dwordx4 v[48:51], v3, s[48:51], s59 offen offset:0 sc1
  buffer_load_dwordx4 v[52:55], v3, s[48:51], s59 offen offset:1024 sc1
  s_mul_i32 s59, s70, 20480
  s_add_u32 s59, s59, 8192
  buffer_load_dwordx4 v[56:59], v3, s[48:51], s59 offen offset:2048 sc1
  buffer_load_dwordx4 v[60:63], v3, s[48:51], s59 offen offset:3072 sc1
  s_mul_i32 s59, s70, 20480
  s_add_u32 s59, s59, 12288
  buffer_load_dwordx4 v[64:67], v3, s[48:51], s59 offen offset:0 sc1
  buffer_load_dwordx4 v[68:71], v3, s[48:51], s59 offen offset:1024 sc1
  buffer_load_dwordx4 v[72:75], v3, s[48:51], s59 offen offset:2048 sc1
  buffer_load_dwordx4 v[76:79], v3, s[48:51], s59 offen offset:3072 sc1
  s_mul_i32 s59, s70, 20480
  s_add_u32 s59, s59, 16384
  buffer_load_dwordx4 v[80:83], v3, s[48:51], s59 offen offset:0 sc1
  buffer_load_dwordx4 v[84:87], v3, s[48:51], s59 offen offset:1024 sc1
  buffer_load_dwordx4 v[88:91], v3, s[48:51], s59 offen offset:2048 sc1
  buffer_load_dwordx4 v[92:95], v3, s[48:51], s59 offen offset:3072 sc1
  v_lshrrev_b32 v9, 4, v2
  v_lshlrev_b32 v8, 4, v9
  s_lshl_b32 s46, s40, 6
  s_add_u32 s46, s46, 0
  v_and_b32 v5, 15, v2
  v_add_u32 v5, s46, v5
  v_lshlrev_b32 v6, 6, v5
  v_add_u32 v6, v6, v8
  buffer_load_dwordx4 v[192:195], v6, s[76:79], 0 offen sc1
  v_lshlrev_b32 v6, 2, v5
  buffer_load_dword v208, v6, s[84:87], 0 offen
  s_lshl_b32 s46, s40, 6
  s_add_u32 s46, s46, 16
  v_and_b32 v5, 15, v2
  v_add_u32 v5, s46, v5
  v_lshlrev_b32 v6, 6, v5
  v_add_u32 v6, v6, v8
  buffer_load_dwordx4 v[196:199], v6, s[76:79], 0 offen sc1
  v_lshlrev_b32 v6, 2, v5
  buffer_load_dword v209, v6, s[84:87], 0 offen
  s_lshl_b32 s46, s40, 6
  s_add_u32 s46, s46, 32
  v_and_b32 v5, 15, v2
  v_add_u32 v5, s46, v5
  v_lshlrev_b32 v6, 6, v5
  v_add_u32 v6, v6, v8
  buffer_load_dwordx4 v[200:203], v6, s[76:79], 0 offen sc1
  v_lshlrev_b32 v6, 2, v5
  buffer_load_dword v210, v6, s[84:87], 0 offen
  s_lshl_b32 s46, s40, 6
  s_add_u32 s46, s46, 48
  v_and_b32 v5, 15, v2
  v_add_u32 v5, s46, v5
  v_lshlrev_b32 v6, 6, v5
  v_add_u32 v6, v6, v8
  buffer_load_dwordx4 v[204:207], v6, s[76:79], 0 offen sc1
  v_lshlrev_b32 v6, 2, v5
  buffer_load_dword v211, v6, s[84:87], 0 offen
  s_mul_i32 s46, s3, 20480
  v_add_u32 v4, s46, v3
  s_waitcnt vmcnt(8)
  s_setprio 2
  ds_write_b128 v4, v[16:19] offset:0
  ds_write_b128 v4, v[20:23] offset:1024
  ds_write_b128 v4, v[24:27] offset:2048
  ds_write_b128 v4, v[28:31] offset:3072
  ds_write_b128 v4, v[32:35] offset:4096
  ds_write_b128 v4, v[36:39] offset:5120
  ds_write_b128 v4, v[40:43] offset:6144
  ds_write_b128 v4, v[44:47] offset:7168
  ds_write_b128 v4, v[48:51] offset:8192
  ds_write_b128 v4, v[52:55] offset:9216
  ds_write_b128 v4, v[56:59] offset:10240
  ds_write_b128 v4, v[60:63] offset:11264
  ds_write_b128 v4, v[64:67] offset:12288
  ds_write_b128 v4, v[68:71] offset:13312
  ds_write_b128 v4, v[72:75] offset:14336
  ds_write_b128 v4, v[76:79] offset:15360
  ds_write_b128 v4, v[80:83] offset:16384
  ds_write_b128 v4, v[84:87] offset:17408
  ds_write_b128 v4, v[88:91] offset:18432
  ds_write_b128 v4, v[92:95] offset:19456
  s_waitcnt vmcnt(0)
  v_add_f32 v220, v220, v221
  v_add_f32 v230, v230, v231
  v_add_f32 v220, v220, v222
  v_add_f32 v230, v230, v232
  v_add_f32 v220, v220, v223
  v_add_f32 v230, v230, v233
  v_add_f32 v220, v220, v224
  v_add_f32 v230, v230, v234
  v_add_f32 v220, v220, v225
  v_add_f32 v230, v230, v235
  v_add_f32 v220, v220, v226
  v_add_f32 v230, v230, v236
  v_add_f32 v220, v220, v227
  v_add_f32 v230, v230, v237
  v_add_f32 v220, v220, v228
  v_add_f32 v230, v230, v238
  v_add_f32 v220, v220, v229
  v_add_f32 v230, v230, v239
  v_add_f32 v251, v220, v230
  v_add_f32 v192, v192, v194
  v_add_f32 v193, v193, v195
  v_mov_b32 v194, v192
  s_nop 1
  v_permlane16_swap_b32 v192, v194
  v_add_f32 v192, v192, v194
  v_mov_b32 v194, v192
  s_nop 1
  v_permlane32_swap_b32 v192, v194
  v_add_f32 v192, v192, v194
  v_mov_b32 v195, v193
  s_nop 1
  v_permlane16_swap_b32 v193, v195
  v_add_f32 v193, v193, v195
  v_mov_b32 v195, v193
  s_nop 1
  v_permlane32_swap_b32 v193, v195
  v_add_f32 v193, v193, v195
  v_mul_f32 v224, 3133983949, v192
  v_mul_f32 v193, 986500301, v193
  v_fma_f32 v193, -v224, v224, v193
  v_add_f32 v193, 925353388, v193
  v_rsq_f32 v193, v193
  v_sub_f32 v194, 1.0, v208
  v_mul_f32 v195, v193, v193
  v_mul_f32 v226, 3222493025, v193
  v_mul_f32 v227, v193, v194
  v_mul_f32 v195, v195, v193
  v_mul_f32 v225, 3184710632, v195
  v_add_f32 v196, v196, v198
  v_add_f32 v197, v197, v199
  v_mov_b32 v198, v196
  s_nop 1
  v_permlane16_swap_b32 v196, v198
  v_add_f32 v196, v196, v198
  v_mov_b32 v198, v196
  s_nop 1
  v_permlane32_swap_b32 v196, v198
  v_add_f32 v196, v196, v198
  v_mov_b32 v199, v197
  s_nop 1
  v_permlane16_swap_b32 v197, v199
  v_add_f32 v197, v197, v199
  v_mov_b32 v199, v197
  s_nop 1
  v_permlane32_swap_b32 v197, v199
  v_add_f32 v197, v197, v199
  v_mul_f32 v228, 3133983949, v196
  v_mul_f32 v197, 986500301, v197
  v_fma_f32 v197, -v228, v228, v197
  v_add_f32 v197, 925353388, v197
  v_rsq_f32 v197, v197
  v_sub_f32 v198, 1.0, v209
  v_mul_f32 v199, v197, v197
  v_mul_f32 v230, 3222493025, v197
  v_mul_f32 v231, v197, v198
  v_mul_f32 v199, v199, v197
  v_mul_f32 v229, 3184710632, v199
  v_add_f32 v200, v200, v202
  v_add_f32 v201, v201, v203
  v_mov_b32 v202, v200
  s_nop 1
  v_permlane16_swap_b32 v200, v202
  v_add_f32 v200, v200, v202
  v_mov_b32 v202, v200
  s_nop 1
  v_permlane32_swap_b32 v200, v202
  v_add_f32 v200, v200, v202
  v_mov_b32 v203, v201
  s_nop 1
  v_permlane16_swap_b32 v201, v203
  v_add_f32 v201, v201, v203
  v_mov_b32 v203, v201
  s_nop 1
  v_permlane32_swap_b32 v201, v203
  v_add_f32 v201, v201, v203
  v_mul_f32 v232, 3133983949, v200
  v_mul_f32 v201, 986500301, v201
  v_fma_f32 v201, -v232, v232, v201
  v_add_f32 v201, 925353388, v201
  v_rsq_f32 v201, v201
  v_sub_f32 v202, 1.0, v210
  v_mul_f32 v203, v201, v201
  v_mul_f32 v234, 3222493025, v201
  v_mul_f32 v235, v201, v202
  v_mul_f32 v203, v203, v201
  v_mul_f32 v233, 3184710632, v203
  v_add_f32 v204, v204, v206
  v_add_f32 v205, v205, v207
  v_mov_b32 v206, v204
  s_nop 1
  v_permlane16_swap_b32 v204, v206
  v_add_f32 v204, v204, v206
  v_mov_b32 v206, v204
  s_nop 1
  v_permlane32_swap_b32 v204, v206
  v_add_f32 v204, v204, v206
  v_mov_b32 v207, v205
  s_nop 1
  v_permlane16_swap_b32 v205, v207
  v_add_f32 v205, v205, v207
  v_mov_b32 v207, v205
  s_nop 1
  v_permlane32_swap_b32 v205, v207
  v_add_f32 v205, v205, v207
  v_mul_f32 v236, 3133983949, v204
  v_mul_f32 v205, 986500301, v205
  v_fma_f32 v205, -v236, v236, v205
  v_add_f32 v205, 925353388, v205
  v_rsq_f32 v205, v205
  v_sub_f32 v206, 1.0, v211
  v_mul_f32 v207, v205, v205
  v_mul_f32 v238, 3222493025, v205
  v_mul_f32 v239, v205, v206
  v_mul_f32 v207, v207, v205
  v_mul_f32 v237, 3184710632, v207
  v_mov_b32 v7, v4
  v_mov_b32 v14, v3
  v_add_u32 v15, 61440, v3
  s_waitcnt lgkmcnt(0)
  s_barrier
  s_setprio 1
  ds_read_b128 v[192:195], v14 offset:0
  ds_read_b128 v[196:199], v14 offset:20480
  ds_read_b128 v[200:203], v14 offset:40960
  ds_read_b128 v[204:207], v15 offset:0
  s_cmp_eq_u32 s93, 4
  s_cselect_b64 vcc, -1, 0
  s_waitcnt lgkmcnt(0)
  s_mov_b32 s59, 6144
  v_mfma_f32_16x16x32_bf16 v[16:19], v[96:99], v[192:195], 0
  ds_read_b128 v[208:211], v14 offset:1024
  v_mfma_f32_16x16x32_bf16 v[32:35], v[96:99], v[196:199], 0
  ds_read_b128 v[212:215], v14 offset:21504
  v_mfma_f32_16x16x32_bf16 v[48:51], v[96:99], v[200:203], 0
  ds_read_b128 v[216:219], v14 offset:41984
  v_mfma_f32_16x16x32_bf16 v[64:67], v[96:99], v[204:207], 0
  ds_read_b128 v[220:223], v15 offset:1024
  buffer_load_dwordx4 v[96:99], v10, s[52:55], s59 offen
  v_mfma_f32_16x16x32_bf16 v[20:23], v[100:103], v[192:195], 0
  v_mfma_f32_16x16x32_bf16 v[36:39], v[100:103], v[196:199], 0
  v_mfma_f32_16x16x32_bf16 v[52:55], v[100:103], v[200:203], 0
  v_mfma_f32_16x16x32_bf16 v[68:71], v[100:103], v[204:207], 0
  buffer_load_dwordx4 v[100:103], v11, s[52:55], s59 offen
  v_mfma_f32_16x16x32_bf16 v[24:27], v[104:107], v[192:195], 0
  v_mfma_f32_16x16x32_bf16 v[40:43], v[104:107], v[196:199], 0
  v_mfma_f32_16x16x32_bf16 v[56:59], v[104:107], v[200:203], 0
  v_mfma_f32_16x16x32_bf16 v[72:75], v[104:107], v[204:207], 0
  buffer_load_dwordx4 v[104:107], v12, s[52:55], s59 offen
  s_cbranch_vccz main_kernel_sk10
  v_mfma_f32_16x16x32_bf16 v[28:31], v[108:111], v[192:195], 0
  v_mfma_f32_16x16x32_bf16 v[44:47], v[108:111], v[196:199], 0
  v_mfma_f32_16x16x32_bf16 v[60:63], v[108:111], v[200:203], 0
  v_mfma_f32_16x16x32_bf16 v[76:79], v[108:111], v[204:207], 0
main_kernel_sk10:
  buffer_load_dwordx4 v[108:111], v13, s[52:55], s59 offen
  s_waitcnt lgkmcnt(0)
  s_mov_b32 s59, 7168
  v_mfma_f32_16x16x32_bf16 v[16:19], v[112:115], v[208:211], v[16:19]
  ds_read_b128 v[192:195], v14 offset:2048
  v_mfma_f32_16x16x32_bf16 v[32:35], v[112:115], v[212:215], v[32:35]
  ds_read_b128 v[196:199], v14 offset:22528
  v_mfma_f32_16x16x32_bf16 v[48:51], v[112:115], v[216:219], v[48:51]
  ds_read_b128 v[200:203], v14 offset:43008
  v_mfma_f32_16x16x32_bf16 v[64:67], v[112:115], v[220:223], v[64:67]
  ds_read_b128 v[204:207], v15 offset:2048
  buffer_load_dwordx4 v[112:115], v10, s[52:55], s59 offen
  v_mfma_f32_16x16x32_bf16 v[20:23], v[116:119], v[208:211], v[20:23]
  v_mfma_f32_16x16x32_bf16 v[36:39], v[116:119], v[212:215], v[36:39]
  v_mfma_f32_16x16x32_bf16 v[52:55], v[116:119], v[216:219], v[52:55]
  v_mfma_f32_16x16x32_bf16 v[68:71], v[116:119], v[220:223], v[68:71]
  buffer_load_dwordx4 v[116:119], v11, s[52:55], s59 offen
  v_mfma_f32_16x16x32_bf16 v[24:27], v[120:123], v[208:211], v[24:27]
  v_mfma_f32_16x16x32_bf16 v[40:43], v[120:123], v[212:215], v[40:43]
  v_mfma_f32_16x16x32_bf16 v[56:59], v[120:123], v[216:219], v[56:59]
  v_mfma_f32_16x16x32_bf16 v[72:75], v[120:123], v[220:223], v[72:75]
  buffer_load_dwordx4 v[120:123], v12, s[52:55], s59 offen
  s_cbranch_vccz main_kernel_sk11
  v_mfma_f32_16x16x32_bf16 v[28:31], v[124:127], v[208:211], v[28:31]
  v_mfma_f32_16x16x32_bf16 v[44:47], v[124:127], v[212:215], v[44:47]
  v_mfma_f32_16x16x32_bf16 v[60:63], v[124:127], v[216:219], v[60:63]
  v_mfma_f32_16x16x32_bf16 v[76:79], v[124:127], v[220:223], v[76:79]
main_kernel_sk11:
  buffer_load_dwordx4 v[124:127], v13, s[52:55], s59 offen
  s_waitcnt lgkmcnt(0)
  s_mov_b32 s59, 8192
  v_mfma_f32_16x16x32_bf16 v[16:19], v[128:131], v[192:195], v[16:19]
  ds_read_b128 v[208:211], v14 offset:3072
  v_mfma_f32_16x16x32_bf16 v[32:35], v[128:131], v[196:199], v[32:35]
  ds_read_b128 v[212:215], v14 offset:23552
  v_mfma_f32_16x16x32_bf16 v[48:51], v[128:131], v[200:203], v[48:51]
  ds_read_b128 v[216:219], v14 offset:44032
  v_mfma_f32_16x16x32_bf16 v[64:67], v[128:131], v[204:207], v[64:67]
  ds_read_b128 v[220:223], v15 offset:3072
  buffer_load_dwordx4 v[128:131], v10, s[52:55], s59 offen
  v_mfma_f32_16x16x32_bf16 v[20:23], v[132:135], v[192:195], v[20:23]
  v_mfma_f32_16x16x32_bf16 v[36:39], v[132:135], v[196:199], v[36:39]
  v_mfma_f32_16x16x32_bf16 v[52:55], v[132:135], v[200:203], v[52:55]
  v_mfma_f32_16x16x32_bf16 v[68:71], v[132:135], v[204:207], v[68:71]
  buffer_load_dwordx4 v[132:135], v11, s[52:55], s59 offen
  v_mfma_f32_16x16x32_bf16 v[24:27], v[136:139], v[192:195], v[24:27]
  v_mfma_f32_16x16x32_bf16 v[40:43], v[136:139], v[196:199], v[40:43]
  v_mfma_f32_16x16x32_bf16 v[56:59], v[136:139], v[200:203], v[56:59]
  v_mfma_f32_16x16x32_bf16 v[72:75], v[136:139], v[204:207], v[72:75]
  buffer_load_dwordx4 v[136:139], v12, s[52:55], s59 offen
  s_cbranch_vccz main_kernel_sk12
  v_mfma_f32_16x16x32_bf16 v[28:31], v[140:143], v[192:195], v[28:31]
  v_mfma_f32_16x16x32_bf16 v[44:47], v[140:143], v[196:199], v[44:47]
  v_mfma_f32_16x16x32_bf16 v[60:63], v[140:143], v[200:203], v[60:63]
  v_mfma_f32_16x16x32_bf16 v[76:79], v[140:143], v[204:207], v[76:79]
main_kernel_sk12:
  buffer_load_dwordx4 v[140:143], v13, s[52:55], s59 offen
  s_waitcnt lgkmcnt(0)
  s_mov_b32 s59, 9216
  v_mfma_f32_16x16x32_bf16 v[16:19], v[144:147], v[208:211], v[16:19]
  ds_read_b128 v[192:195], v14 offset:4096
  v_mfma_f32_16x16x32_bf16 v[32:35], v[144:147], v[212:215], v[32:35]
  ds_read_b128 v[196:199], v14 offset:24576
  v_mfma_f32_16x16x32_bf16 v[48:51], v[144:147], v[216:219], v[48:51]
  ds_read_b128 v[200:203], v14 offset:45056
  v_mfma_f32_16x16x32_bf16 v[64:67], v[144:147], v[220:223], v[64:67]
  ds_read_b128 v[204:207], v15 offset:4096
  buffer_load_dwordx4 v[144:147], v10, s[52:55], s59 offen
  v_mfma_f32_16x16x32_bf16 v[20:23], v[148:151], v[208:211], v[20:23]
  v_mfma_f32_16x16x32_bf16 v[36:39], v[148:151], v[212:215], v[36:39]
  v_mfma_f32_16x16x32_bf16 v[52:55], v[148:151], v[216:219], v[52:55]
  v_mfma_f32_16x16x32_bf16 v[68:71], v[148:151], v[220:223], v[68:71]
  buffer_load_dwordx4 v[148:151], v11, s[52:55], s59 offen
  v_mfma_f32_16x16x32_bf16 v[24:27], v[152:155], v[208:211], v[24:27]
  v_mfma_f32_16x16x32_bf16 v[40:43], v[152:155], v[212:215], v[40:43]
  v_mfma_f32_16x16x32_bf16 v[56:59], v[152:155], v[216:219], v[56:59]
  v_mfma_f32_16x16x32_bf16 v[72:75], v[152:155], v[220:223], v[72:75]
  buffer_load_dwordx4 v[152:155], v12, s[52:55], s59 offen
  s_cbranch_vccz main_kernel_sk13
  v_mfma_f32_16x16x32_bf16 v[28:31], v[156:159], v[208:211], v[28:31]
  v_mfma_f32_16x16x32_bf16 v[44:47], v[156:159], v[212:215], v[44:47]
  v_mfma_f32_16x16x32_bf16 v[60:63], v[156:159], v[216:219], v[60:63]
  v_mfma_f32_16x16x32_bf16 v[76:79], v[156:159], v[220:223], v[76:79]
main_kernel_sk13:
  buffer_load_dwordx4 v[156:159], v13, s[52:55], s59 offen
  s_waitcnt lgkmcnt(0)
  s_mov_b32 s59, 10240
  v_mfma_f32_16x16x32_bf16 v[16:19], v[160:163], v[192:195], v[16:19]
  ds_read_b128 v[208:211], v14 offset:5120
  v_mfma_f32_16x16x32_bf16 v[32:35], v[160:163], v[196:199], v[32:35]
  ds_read_b128 v[212:215], v14 offset:25600
  v_mfma_f32_16x16x32_bf16 v[48:51], v[160:163], v[200:203], v[48:51]
  ds_read_b128 v[216:219], v14 offset:46080
  v_mfma_f32_16x16x32_bf16 v[64:67], v[160:163], v[204:207], v[64:67]
  ds_read_b128 v[220:223], v15 offset:5120
  buffer_load_dwordx4 v[160:163], v10, s[52:55], s59 offen
  v_mfma_f32_16x16x32_bf16 v[20:23], v[164:167], v[192:195], v[20:23]
  v_mfma_f32_16x16x32_bf16 v[36:39], v[164:167], v[196:199], v[36:39]
  v_mfma_f32_16x16x32_bf16 v[52:55], v[164:167], v[200:203], v[52:55]
  v_mfma_f32_16x16x32_bf16 v[68:71], v[164:167], v[204:207], v[68:71]
  buffer_load_dwordx4 v[164:167], v11, s[52:55], s59 offen
  v_mfma_f32_16x16x32_bf16 v[24:27], v[168:171], v[192:195], v[24:27]
  v_mfma_f32_16x16x32_bf16 v[40:43], v[168:171], v[196:199], v[40:43]
  v_mfma_f32_16x16x32_bf16 v[56:59], v[168:171], v[200:203], v[56:59]
  v_mfma_f32_16x16x32_bf16 v[72:75], v[168:171], v[204:207], v[72:75]
  buffer_load_dwordx4 v[168:171], v12, s[52:55], s59 offen
  s_cbranch_vccz main_kernel_sk14
  v_mfma_f32_16x16x32_bf16 v[28:31], v[172:175], v[192:195], v[28:31]
  v_mfma_f32_16x16x32_bf16 v[44:47], v[172:175], v[196:199], v[44:47]
  v_mfma_f32_16x16x32_bf16 v[60:63], v[172:175], v[200:203], v[60:63]
  v_mfma_f32_16x16x32_bf16 v[76:79], v[172:175], v[204:207], v[76:79]
main_kernel_sk14:
  buffer_load_dwordx4 v[172:175], v13, s[52:55], s59 offen
  s_waitcnt lgkmcnt(0)
  s_mov_b32 s59, 11264
  v_mfma_f32_16x16x32_bf16 v[16:19], v[176:179], v[208:211], v[16:19]
  ds_read_b128 v[192:195], v14 offset:6144
  v_mfma_f32_16x16x32_bf16 v[32:35], v[176:179], v[212:215], v[32:35]
  ds_read_b128 v[196:199], v14 offset:26624
  v_mfma_f32_16x16x32_bf16 v[48:51], v[176:179], v[216:219], v[48:51]
  ds_read_b128 v[200:203], v14 offset:47104
  v_mfma_f32_16x16x32_bf16 v[64:67], v[176:179], v[220:223], v[64:67]
  ds_read_b128 v[204:207], v15 offset:6144
  buffer_load_dwordx4 v[176:179], v10, s[52:55], s59 offen
  v_mfma_f32_16x16x32_bf16 v[20:23], v[180:183], v[208:211], v[20:23]
  v_mfma_f32_16x16x32_bf16 v[36:39], v[180:183], v[212:215], v[36:39]
  v_mfma_f32_16x16x32_bf16 v[52:55], v[180:183], v[216:219], v[52:55]
  v_mfma_f32_16x16x32_bf16 v[68:71], v[180:183], v[220:223], v[68:71]
  buffer_load_dwordx4 v[180:183], v11, s[52:55], s59 offen
  v_mfma_f32_16x16x32_bf16 v[24:27], v[184:187], v[208:211], v[24:27]
  v_mfma_f32_16x16x32_bf16 v[40:43], v[184:187], v[212:215], v[40:43]
  v_mfma_f32_16x16x32_bf16 v[56:59], v[184:187], v[216:219], v[56:59]
  v_mfma_f32_16x16x32_bf16 v[72:75], v[184:187], v[220:223], v[72:75]
  buffer_load_dwordx4 v[184:187], v12, s[52:55], s59 offen
  s_cbranch_vccz main_kernel_sk15
  v_mfma_f32_16x16x32_bf16 v[28:31], v[188:191], v[208:211], v[28:31]
  v_mfma_f32_16x16x32_bf16 v[44:47], v[188:191], v[212:215], v[44:47]
  v_mfma_f32_16x16x32_bf16 v[60:63], v[188:191], v[216:219], v[60:63]
  v_mfma_f32_16x16x32_bf16 v[76:79], v[188:191], v[220:223], v[76:79]
main_kernel_sk15:
  buffer_load_dwordx4 v[188:191], v13, s[52:55], s59 offen
  s_waitcnt vmcnt(20)
  s_waitcnt lgkmcnt(0)
  s_mov_b32 s59, 12288
  v_mfma_f32_16x16x32_bf16 v[16:19], v[96:99], v[192:195], v[16:19]
  ds_read_b128 v[208:211], v14 offset:7168
  v_mfma_f32_16x16x32_bf16 v[32:35], v[96:99], v[196:199], v[32:35]
  ds_read_b128 v[212:215], v14 offset:27648
  v_mfma_f32_16x16x32_bf16 v[48:51], v[96:99], v[200:203], v[48:51]
  ds_read_b128 v[216:219], v14 offset:48128
  v_mfma_f32_16x16x32_bf16 v[64:67], v[96:99], v[204:207], v[64:67]
  ds_read_b128 v[220:223], v15 offset:7168
  buffer_load_dwordx4 v[96:99], v10, s[52:55], s59 offen
  v_mfma_f32_16x16x32_bf16 v[20:23], v[100:103], v[192:195], v[20:23]
  v_mfma_f32_16x16x32_bf16 v[36:39], v[100:103], v[196:199], v[36:39]
  v_mfma_f32_16x16x32_bf16 v[52:55], v[100:103], v[200:203], v[52:55]
  v_mfma_f32_16x16x32_bf16 v[68:71], v[100:103], v[204:207], v[68:71]
  buffer_load_dwordx4 v[100:103], v11, s[52:55], s59 offen
  v_mfma_f32_16x16x32_bf16 v[24:27], v[104:107], v[192:195], v[24:27]
  v_mfma_f32_16x16x32_bf16 v[40:43], v[104:107], v[196:199], v[40:43]
  v_mfma_f32_16x16x32_bf16 v[56:59], v[104:107], v[200:203], v[56:59]
  v_mfma_f32_16x16x32_bf16 v[72:75], v[104:107], v[204:207], v[72:75]
  buffer_load_dwordx4 v[104:107], v12, s[52:55], s59 offen
  s_cbranch_vccz main_kernel_sk16
  v_mfma_f32_16x16x32_bf16 v[28:31], v[108:111], v[192:195], v[28:31]
  v_mfma_f32_16x16x32_bf16 v[44:47], v[108:111], v[196:199], v[44:47]
  v_mfma_f32_16x16x32_bf16 v[60:63], v[108:111], v[200:203], v[60:63]
  v_mfma_f32_16x16x32_bf16 v[76:79], v[108:111], v[204:207], v[76:79]
main_kernel_sk16:
  buffer_load_dwordx4 v[108:111], v13, s[52:55], s59 offen
  s_waitcnt vmcnt(20)
  s_waitcnt lgkmcnt(0)
  s_mov_b32 s59, 13312
  v_mfma_f32_16x16x32_bf16 v[16:19], v[112:115], v[208:211], v[16:19]
  ds_read_b128 v[192:195], v14 offset:8192
  v_mfma_f32_16x16x32_bf16 v[32:35], v[112:115], v[212:215], v[32:35]
  ds_read_b128 v[196:199], v14 offset:28672
  v_mfma_f32_16x16x32_bf16 v[48:51], v[112:115], v[216:219], v[48:51]
  ds_read_b128 v[200:203], v14 offset:49152
  v_mfma_f32_16x16x32_bf16 v[64:67], v[112:115], v[220:223], v[64:67]
  ds_read_b128 v[204:207], v15 offset:8192
  buffer_load_dwordx4 v[112:115], v10, s[52:55], s59 offen
  v_mfma_f32_16x16x32_bf16 v[20:23], v[116:119], v[208:211], v[20:23]
  v_mfma_f32_16x16x32_bf16 v[36:39], v[116:119], v[212:215], v[36:39]
  v_mfma_f32_16x16x32_bf16 v[52:55], v[116:119], v[216:219], v[52:55]
  v_mfma_f32_16x16x32_bf16 v[68:71], v[116:119], v[220:223], v[68:71]
  buffer_load_dwordx4 v[116:119], v11, s[52:55], s59 offen
  v_mfma_f32_16x16x32_bf16 v[24:27], v[120:123], v[208:211], v[24:27]
  v_mfma_f32_16x16x32_bf16 v[40:43], v[120:123], v[212:215], v[40:43]
  v_mfma_f32_16x16x32_bf16 v[56:59], v[120:123], v[216:219], v[56:59]
  v_mfma_f32_16x16x32_bf16 v[72:75], v[120:123], v[220:223], v[72:75]
  buffer_load_dwordx4 v[120:123], v12, s[52:55], s59 offen
  s_cbranch_vccz main_kernel_sk17
  v_mfma_f32_16x16x32_bf16 v[28:31], v[124:127], v[208:211], v[28:31]
  v_mfma_f32_16x16x32_bf16 v[44:47], v[124:127], v[212:215], v[44:47]
  v_mfma_f32_16x16x32_bf16 v[60:63], v[124:127], v[216:219], v[60:63]
  v_mfma_f32_16x16x32_bf16 v[76:79], v[124:127], v[220:223], v[76:79]
main_kernel_sk17:
  buffer_load_dwordx4 v[124:127], v13, s[52:55], s59 offen
  s_waitcnt vmcnt(20)
  s_waitcnt lgkmcnt(0)
  s_mov_b32 s59, 14336
  v_mfma_f32_16x16x32_bf16 v[16:19], v[128:131], v[192:195], v[16:19]
  ds_read_b128 v[208:211], v14 offset:9216
  v_mfma_f32_16x16x32_bf16 v[32:35], v[128:131], v[196:199], v[32:35]
  ds_read_b128 v[212:215], v14 offset:29696
  v_mfma_f32_16x16x32_bf16 v[48:51], v[128:131], v[200:203], v[48:51]
  ds_read_b128 v[216:219], v14 offset:50176
  v_mfma_f32_16x16x32_bf16 v[64:67], v[128:131], v[204:207], v[64:67]
  ds_read_b128 v[220:223], v15 offset:9216
  buffer_load_dwordx4 v[128:131], v10, s[52:55], s59 offen
  v_mfma_f32_16x16x32_bf16 v[20:23], v[132:135], v[192:195], v[20:23]
  v_mfma_f32_16x16x32_bf16 v[36:39], v[132:135], v[196:199], v[36:39]
  v_mfma_f32_16x16x32_bf16 v[52:55], v[132:135], v[200:203], v[52:55]
  v_mfma_f32_16x16x32_bf16 v[68:71], v[132:135], v[204:207], v[68:71]
  buffer_load_dwordx4 v[132:135], v11, s[52:55], s59 offen
  v_mfma_f32_16x16x32_bf16 v[24:27], v[136:139], v[192:195], v[24:27]
  v_mfma_f32_16x16x32_bf16 v[40:43], v[136:139], v[196:199], v[40:43]
  v_mfma_f32_16x16x32_bf16 v[56:59], v[136:139], v[200:203], v[56:59]
  v_mfma_f32_16x16x32_bf16 v[72:75], v[136:139], v[204:207], v[72:75]
  buffer_load_dwordx4 v[136:139], v12, s[52:55], s59 offen
  s_cbranch_vccz main_kernel_sk18
  v_mfma_f32_16x16x32_bf16 v[28:31], v[140:143], v[192:195], v[28:31]
  v_mfma_f32_16x16x32_bf16 v[44:47], v[140:143], v[196:199], v[44:47]
  v_mfma_f32_16x16x32_bf16 v[60:63], v[140:143], v[200:203], v[60:63]
  v_mfma_f32_16x16x32_bf16 v[76:79], v[140:143], v[204:207], v[76:79]
main_kernel_sk18:
  buffer_load_dwordx4 v[140:143], v13, s[52:55], s59 offen
  s_waitcnt vmcnt(20)
  s_waitcnt lgkmcnt(0)
  s_mov_b32 s59, 15360
  v_mfma_f32_16x16x32_bf16 v[16:19], v[144:147], v[208:211], v[16:19]
  ds_read_b128 v[192:195], v14 offset:10240
  v_mfma_f32_16x16x32_bf16 v[32:35], v[144:147], v[212:215], v[32:35]
  ds_read_b128 v[196:199], v14 offset:30720
  v_mfma_f32_16x16x32_bf16 v[48:51], v[144:147], v[216:219], v[48:51]
  ds_read_b128 v[200:203], v14 offset:51200
  v_mfma_f32_16x16x32_bf16 v[64:67], v[144:147], v[220:223], v[64:67]
  ds_read_b128 v[204:207], v15 offset:10240
  buffer_load_dwordx4 v[144:147], v10, s[52:55], s59 offen
  v_mfma_f32_16x16x32_bf16 v[20:23], v[148:151], v[208:211], v[20:23]
  v_mfma_f32_16x16x32_bf16 v[36:39], v[148:151], v[212:215], v[36:39]
  v_mfma_f32_16x16x32_bf16 v[52:55], v[148:151], v[216:219], v[52:55]
  v_mfma_f32_16x16x32_bf16 v[68:71], v[148:151], v[220:223], v[68:71]
  buffer_load_dwordx4 v[148:151], v11, s[52:55], s59 offen
  v_mfma_f32_16x16x32_bf16 v[24:27], v[152:155], v[208:211], v[24:27]
  v_mfma_f32_16x16x32_bf16 v[40:43], v[152:155], v[212:215], v[40:43]
  v_mfma_f32_16x16x32_bf16 v[56:59], v[152:155], v[216:219], v[56:59]
  v_mfma_f32_16x16x32_bf16 v[72:75], v[152:155], v[220:223], v[72:75]
  buffer_load_dwordx4 v[152:155], v12, s[52:55], s59 offen
  s_cbranch_vccz main_kernel_sk19
  v_mfma_f32_16x16x32_bf16 v[28:31], v[156:159], v[208:211], v[28:31]
  v_mfma_f32_16x16x32_bf16 v[44:47], v[156:159], v[212:215], v[44:47]
  v_mfma_f32_16x16x32_bf16 v[60:63], v[156:159], v[216:219], v[60:63]
  v_mfma_f32_16x16x32_bf16 v[76:79], v[156:159], v[220:223], v[76:79]
main_kernel_sk19:
  buffer_load_dwordx4 v[156:159], v13, s[52:55], s59 offen
  s_waitcnt vmcnt(20)
  s_waitcnt lgkmcnt(0)
  s_mov_b32 s59, 16384
  v_mfma_f32_16x16x32_bf16 v[16:19], v[160:163], v[192:195], v[16:19]
  ds_read_b128 v[208:211], v14 offset:11264
  v_mfma_f32_16x16x32_bf16 v[32:35], v[160:163], v[196:199], v[32:35]
  ds_read_b128 v[212:215], v14 offset:31744
  v_mfma_f32_16x16x32_bf16 v[48:51], v[160:163], v[200:203], v[48:51]
  ds_read_b128 v[216:219], v14 offset:52224
  v_mfma_f32_16x16x32_bf16 v[64:67], v[160:163], v[204:207], v[64:67]
  ds_read_b128 v[220:223], v15 offset:11264
  buffer_load_dwordx4 v[160:163], v10, s[52:55], s59 offen
  v_mfma_f32_16x16x32_bf16 v[20:23], v[164:167], v[192:195], v[20:23]
  v_mfma_f32_16x16x32_bf16 v[36:39], v[164:167], v[196:199], v[36:39]
  v_mfma_f32_16x16x32_bf16 v[52:55], v[164:167], v[200:203], v[52:55]
  v_mfma_f32_16x16x32_bf16 v[68:71], v[164:167], v[204:207], v[68:71]
  buffer_load_dwordx4 v[164:167], v11, s[52:55], s59 offen
  v_mfma_f32_16x16x32_bf16 v[24:27], v[168:171], v[192:195], v[24:27]
  v_mfma_f32_16x16x32_bf16 v[40:43], v[168:171], v[196:199], v[40:43]
  v_mfma_f32_16x16x32_bf16 v[56:59], v[168:171], v[200:203], v[56:59]
  v_mfma_f32_16x16x32_bf16 v[72:75], v[168:171], v[204:207], v[72:75]
  buffer_load_dwordx4 v[168:171], v12, s[52:55], s59 offen
  s_cbranch_vccz main_kernel_sk20
  v_mfma_f32_16x16x32_bf16 v[28:31], v[172:175], v[192:195], v[28:31]
  v_mfma_f32_16x16x32_bf16 v[44:47], v[172:175], v[196:199], v[44:47]
  v_mfma_f32_16x16x32_bf16 v[60:63], v[172:175], v[200:203], v[60:63]
  v_mfma_f32_16x16x32_bf16 v[76:79], v[172:175], v[204:207], v[76:79]
main_kernel_sk20:
  buffer_load_dwordx4 v[172:175], v13, s[52:55], s59 offen
  s_waitcnt vmcnt(20)
  s_waitcnt lgkmcnt(0)
  s_mov_b32 s59, 17408
  v_mfma_f32_16x16x32_bf16 v[16:19], v[176:179], v[208:211], v[16:19]
  ds_read_b128 v[192:195], v14 offset:12288
  v_mfma_f32_16x16x32_bf16 v[32:35], v[176:179], v[212:215], v[32:35]
  ds_read_b128 v[196:199], v14 offset:32768
  v_mfma_f32_16x16x32_bf16 v[48:51], v[176:179], v[216:219], v[48:51]
  ds_read_b128 v[200:203], v14 offset:53248
  v_mfma_f32_16x16x32_bf16 v[64:67], v[176:179], v[220:223], v[64:67]
  ds_read_b128 v[204:207], v15 offset:12288
  buffer_load_dwordx4 v[176:179], v10, s[52:55], s59 offen
  v_mfma_f32_16x16x32_bf16 v[20:23], v[180:183], v[208:211], v[20:23]
  v_mfma_f32_16x16x32_bf16 v[36:39], v[180:183], v[212:215], v[36:39]
  v_mfma_f32_16x16x32_bf16 v[52:55], v[180:183], v[216:219], v[52:55]
  v_mfma_f32_16x16x32_bf16 v[68:71], v[180:183], v[220:223], v[68:71]
  buffer_load_dwordx4 v[180:183], v11, s[52:55], s59 offen
  v_mfma_f32_16x16x32_bf16 v[24:27], v[184:187], v[208:211], v[24:27]
  v_mfma_f32_16x16x32_bf16 v[40:43], v[184:187], v[212:215], v[40:43]
  v_mfma_f32_16x16x32_bf16 v[56:59], v[184:187], v[216:219], v[56:59]
  v_mfma_f32_16x16x32_bf16 v[72:75], v[184:187], v[220:223], v[72:75]
  buffer_load_dwordx4 v[184:187], v12, s[52:55], s59 offen
  s_cbranch_vccz main_kernel_sk21
  v_mfma_f32_16x16x32_bf16 v[28:31], v[188:191], v[208:211], v[28:31]
  v_mfma_f32_16x16x32_bf16 v[44:47], v[188:191], v[212:215], v[44:47]
  v_mfma_f32_16x16x32_bf16 v[60:63], v[188:191], v[216:219], v[60:63]
  v_mfma_f32_16x16x32_bf16 v[76:79], v[188:191], v[220:223], v[76:79]
main_kernel_sk21:
  buffer_load_dwordx4 v[188:191], v13, s[52:55], s59 offen
  s_waitcnt vmcnt(20)
  s_waitcnt lgkmcnt(0)
  s_mov_b32 s59, 18432
  v_mfma_f32_16x16x32_bf16 v[16:19], v[96:99], v[192:195], v[16:19]
  ds_read_b128 v[208:211], v14 offset:13312
  v_mfma_f32_16x16x32_bf16 v[32:35], v[96:99], v[196:199], v[32:35]
  ds_read_b128 v[212:215], v14 offset:33792
  v_mfma_f32_16x16x32_bf16 v[48:51], v[96:99], v[200:203], v[48:51]
  ds_read_b128 v[216:219], v14 offset:54272
  v_mfma_f32_16x16x32_bf16 v[64:67], v[96:99], v[204:207], v[64:67]
  ds_read_b128 v[220:223], v15 offset:13312
  buffer_load_dwordx4 v[96:99], v10, s[52:55], s59 offen
  v_mfma_f32_16x16x32_bf16 v[20:23], v[100:103], v[192:195], v[20:23]
  v_mfma_f32_16x16x32_bf16 v[36:39], v[100:103], v[196:199], v[36:39]
  v_mfma_f32_16x16x32_bf16 v[52:55], v[100:103], v[200:203], v[52:55]
  v_mfma_f32_16x16x32_bf16 v[68:71], v[100:103], v[204:207], v[68:71]
  buffer_load_dwordx4 v[100:103], v11, s[52:55], s59 offen
  v_mfma_f32_16x16x32_bf16 v[24:27], v[104:107], v[192:195], v[24:27]
  v_mfma_f32_16x16x32_bf16 v[40:43], v[104:107], v[196:199], v[40:43]
  v_mfma_f32_16x16x32_bf16 v[56:59], v[104:107], v[200:203], v[56:59]
  v_mfma_f32_16x16x32_bf16 v[72:75], v[104:107], v[204:207], v[72:75]
  buffer_load_dwordx4 v[104:107], v12, s[52:55], s59 offen
  s_cbranch_vccz main_kernel_sk22
  v_mfma_f32_16x16x32_bf16 v[28:31], v[108:111], v[192:195], v[28:31]
  v_mfma_f32_16x16x32_bf16 v[44:47], v[108:111], v[196:199], v[44:47]
  v_mfma_f32_16x16x32_bf16 v[60:63], v[108:111], v[200:203], v[60:63]
  v_mfma_f32_16x16x32_bf16 v[76:79], v[108:111], v[204:207], v[76:79]
main_kernel_sk22:
  buffer_load_dwordx4 v[108:111], v13, s[52:55], s59 offen
  s_waitcnt vmcnt(20)
  s_waitcnt lgkmcnt(0)
  s_mov_b32 s59, 19456
  v_mfma_f32_16x16x32_bf16 v[16:19], v[112:115], v[208:211], v[16:19]
  ds_read_b128 v[192:195], v14 offset:14336
  v_mfma_f32_16x16x32_bf16 v[32:35], v[112:115], v[212:215], v[32:35]
  ds_read_b128 v[196:199], v14 offset:34816
  v_mfma_f32_16x16x32_bf16 v[48:51], v[112:115], v[216:219], v[48:51]
  ds_read_b128 v[200:203], v14 offset:55296
  v_mfma_f32_16x16x32_bf16 v[64:67], v[112:115], v[220:223], v[64:67]
  ds_read_b128 v[204:207], v15 offset:14336
  buffer_load_dwordx4 v[112:115], v10, s[52:55], s59 offen
  v_mfma_f32_16x16x32_bf16 v[20:23], v[116:119], v[208:211], v[20:23]
  v_mfma_f32_16x16x32_bf16 v[36:39], v[116:119], v[212:215], v[36:39]
  v_mfma_f32_16x16x32_bf16 v[52:55], v[116:119], v[216:219], v[52:55]
  v_mfma_f32_16x16x32_bf16 v[68:71], v[116:119], v[220:223], v[68:71]
  buffer_load_dwordx4 v[116:119], v11, s[52:55], s59 offen
  v_mfma_f32_16x16x32_bf16 v[24:27], v[120:123], v[208:211], v[24:27]
  v_mfma_f32_16x16x32_bf16 v[40:43], v[120:123], v[212:215], v[40:43]
  v_mfma_f32_16x16x32_bf16 v[56:59], v[120:123], v[216:219], v[56:59]
  v_mfma_f32_16x16x32_bf16 v[72:75], v[120:123], v[220:223], v[72:75]
  buffer_load_dwordx4 v[120:123], v12, s[52:55], s59 offen
  s_cbranch_vccz main_kernel_sk23
  v_mfma_f32_16x16x32_bf16 v[28:31], v[124:127], v[208:211], v[28:31]
  v_mfma_f32_16x16x32_bf16 v[44:47], v[124:127], v[212:215], v[44:47]
  v_mfma_f32_16x16x32_bf16 v[60:63], v[124:127], v[216:219], v[60:63]
  v_mfma_f32_16x16x32_bf16 v[76:79], v[124:127], v[220:223], v[76:79]
main_kernel_sk23:
  buffer_load_dwordx4 v[124:127], v13, s[52:55], s59 offen
  s_waitcnt vmcnt(20)
  s_waitcnt lgkmcnt(0)
  v_mfma_f32_16x16x32_bf16 v[16:19], v[128:131], v[192:195], v[16:19]
  ds_read_b128 v[208:211], v14 offset:15360
  v_mfma_f32_16x16x32_bf16 v[32:35], v[128:131], v[196:199], v[32:35]
  ds_read_b128 v[212:215], v14 offset:35840
  v_mfma_f32_16x16x32_bf16 v[48:51], v[128:131], v[200:203], v[48:51]
  ds_read_b128 v[216:219], v14 offset:56320
  v_mfma_f32_16x16x32_bf16 v[64:67], v[128:131], v[204:207], v[64:67]
  ds_read_b128 v[220:223], v15 offset:15360
  v_mfma_f32_16x16x32_bf16 v[20:23], v[132:135], v[192:195], v[20:23]
  v_mfma_f32_16x16x32_bf16 v[36:39], v[132:135], v[196:199], v[36:39]
  v_mfma_f32_16x16x32_bf16 v[52:55], v[132:135], v[200:203], v[52:55]
  v_mfma_f32_16x16x32_bf16 v[68:71], v[132:135], v[204:207], v[68:71]
  v_mfma_f32_16x16x32_bf16 v[24:27], v[136:139], v[192:195], v[24:27]
  v_mfma_f32_16x16x32_bf16 v[40:43], v[136:139], v[196:199], v[40:43]
  v_mfma_f32_16x16x32_bf16 v[56:59], v[136:139], v[200:203], v[56:59]
  v_mfma_f32_16x16x32_bf16 v[72:75], v[136:139], v[204:207], v[72:75]
  s_cbranch_vccz main_kernel_sk24
  v_mfma_f32_16x16x32_bf16 v[28:31], v[140:143], v[192:195], v[28:31]
  v_mfma_f32_16x16x32_bf16 v[44:47], v[140:143], v[196:199], v[44:47]
  v_mfma_f32_16x16x32_bf16 v[60:63], v[140:143], v[200:203], v[60:63]
  v_mfma_f32_16x16x32_bf16 v[76:79], v[140:143], v[204:207], v[76:79]
main_kernel_sk24:
  ds_bpermute_b32 v128, v8, v251 offset:0
  ds_bpermute_b32 v129, v8, v251 offset:4
  ds_bpermute_b32 v130, v8, v251 offset:8
  ds_bpermute_b32 v131, v8, v251 offset:12
  ds_bpermute_b32 v132, v8, v251 offset:64
  ds_bpermute_b32 v133, v8, v251 offset:68
  ds_bpermute_b32 v134, v8, v251 offset:72
  ds_bpermute_b32 v135, v8, v251 offset:76
  s_waitcnt vmcnt(16)
  s_waitcnt lgkmcnt(0)
  v_mfma_f32_16x16x32_bf16 v[16:19], v[144:147], v[208:211], v[16:19]
  ds_read_b128 v[192:195], v14 offset:16384
  v_mfma_f32_16x16x32_bf16 v[32:35], v[144:147], v[212:215], v[32:35]
  ds_read_b128 v[196:199], v14 offset:36864
  v_mfma_f32_16x16x32_bf16 v[48:51], v[144:147], v[216:219], v[48:51]
  ds_read_b128 v[200:203], v14 offset:57344
  v_mfma_f32_16x16x32_bf16 v[64:67], v[144:147], v[220:223], v[64:67]
  ds_read_b128 v[204:207], v15 offset:16384
  v_mfma_f32_16x16x32_bf16 v[20:23], v[148:151], v[208:211], v[20:23]
  v_mfma_f32_16x16x32_bf16 v[36:39], v[148:151], v[212:215], v[36:39]
  v_mfma_f32_16x16x32_bf16 v[52:55], v[148:151], v[216:219], v[52:55]
  v_mfma_f32_16x16x32_bf16 v[68:71], v[148:151], v[220:223], v[68:71]
  v_mfma_f32_16x16x32_bf16 v[24:27], v[152:155], v[208:211], v[24:27]
  v_mfma_f32_16x16x32_bf16 v[40:43], v[152:155], v[212:215], v[40:43]
  v_mfma_f32_16x16x32_bf16 v[56:59], v[152:155], v[216:219], v[56:59]
  v_mfma_f32_16x16x32_bf16 v[72:75], v[152:155], v[220:223], v[72:75]
  s_cbranch_vccz main_kernel_sk25
  v_mfma_f32_16x16x32_bf16 v[28:31], v[156:159], v[208:211], v[28:31]
  v_mfma_f32_16x16x32_bf16 v[44:47], v[156:159], v[212:215], v[44:47]
  v_mfma_f32_16x16x32_bf16 v[60:63], v[156:159], v[216:219], v[60:63]
  v_mfma_f32_16x16x32_bf16 v[76:79], v[156:159], v[220:223], v[76:79]
main_kernel_sk25:
  ds_bpermute_b32 v136, v8, v251 offset:128
  ds_bpermute_b32 v137, v8, v251 offset:132
  ds_bpermute_b32 v138, v8, v251 offset:136
  ds_bpermute_b32 v139, v8, v251 offset:140
  ds_bpermute_b32 v140, v8, v251 offset:192
  ds_bpermute_b32 v141, v8, v251 offset:196
  ds_bpermute_b32 v142, v8, v251 offset:200
  ds_bpermute_b32 v143, v8, v251 offset:204
  s_waitcnt vmcnt(12)
  s_waitcnt lgkmcnt(0)
  v_mfma_f32_16x16x32_bf16 v[16:19], v[160:163], v[192:195], v[16:19]
  ds_read_b128 v[208:211], v14 offset:17408
  v_mfma_f32_16x16x32_bf16 v[32:35], v[160:163], v[196:199], v[32:35]
  ds_read_b128 v[212:215], v14 offset:37888
  v_mfma_f32_16x16x32_bf16 v[48:51], v[160:163], v[200:203], v[48:51]
  ds_read_b128 v[216:219], v14 offset:58368
  v_mfma_f32_16x16x32_bf16 v[64:67], v[160:163], v[204:207], v[64:67]
  ds_read_b128 v[220:223], v15 offset:17408
  v_mfma_f32_16x16x32_bf16 v[20:23], v[164:167], v[192:195], v[20:23]
  v_mfma_f32_16x16x32_bf16 v[36:39], v[164:167], v[196:199], v[36:39]
  v_mfma_f32_16x16x32_bf16 v[52:55], v[164:167], v[200:203], v[52:55]
  v_mfma_f32_16x16x32_bf16 v[68:71], v[164:167], v[204:207], v[68:71]
  v_mfma_f32_16x16x32_bf16 v[24:27], v[168:171], v[192:195], v[24:27]
  v_mfma_f32_16x16x32_bf16 v[40:43], v[168:171], v[196:199], v[40:43]
  v_mfma_f32_16x16x32_bf16 v[56:59], v[168:171], v[200:203], v[56:59]
  v_mfma_f32_16x16x32_bf16 v[72:75], v[168:171], v[204:207], v[72:75]
  s_cbranch_vccz main_kernel_sk26
  v_mfma_f32_16x16x32_bf16 v[28:31], v[172:175], v[192:195], v[28:31]
  v_mfma_f32_16x16x32_bf16 v[44:47], v[172:175], v[196:199], v[44:47]
  v_mfma_f32_16x16x32_bf16 v[60:63], v[172:175], v[200:203], v[60:63]
  v_mfma_f32_16x16x32_bf16 v[76:79], v[172:175], v[204:207], v[76:79]
main_kernel_sk26:
  s_waitcnt vmcnt(8)
  s_waitcnt lgkmcnt(0)
  v_mfma_f32_16x16x32_bf16 v[16:19], v[176:179], v[208:211], v[16:19]
  ds_read_b128 v[192:195], v14 offset:18432
  v_mfma_f32_16x16x32_bf16 v[32:35], v[176:179], v[212:215], v[32:35]
  ds_read_b128 v[196:199], v14 offset:38912
  v_mfma_f32_16x16x32_bf16 v[48:51], v[176:179], v[216:219], v[48:51]
  ds_read_b128 v[200:203], v14 offset:59392
  v_mfma_f32_16x16x32_bf16 v[64:67], v[176:179], v[220:223], v[64:67]
  ds_read_b128 v[204:207], v15 offset:18432
  v_mfma_f32_16x16x32_bf16 v[20:23], v[180:183], v[208:211], v[20:23]
  v_mfma_f32_16x16x32_bf16 v[36:39], v[180:183], v[212:215], v[36:39]
  v_mfma_f32_16x16x32_bf16 v[52:55], v[180:183], v[216:219], v[52:55]
  v_mfma_f32_16x16x32_bf16 v[68:71], v[180:183], v[220:223], v[68:71]
  v_mfma_f32_16x16x32_bf16 v[24:27], v[184:187], v[208:211], v[24:27]
  v_mfma_f32_16x16x32_bf16 v[40:43], v[184:187], v[212:215], v[40:43]
  v_mfma_f32_16x16x32_bf16 v[56:59], v[184:187], v[216:219], v[56:59]
  v_mfma_f32_16x16x32_bf16 v[72:75], v[184:187], v[220:223], v[72:75]
  s_cbranch_vccz main_kernel_sk27
  v_mfma_f32_16x16x32_bf16 v[28:31], v[188:191], v[208:211], v[28:31]
  v_mfma_f32_16x16x32_bf16 v[44:47], v[188:191], v[212:215], v[44:47]
  v_mfma_f32_16x16x32_bf16 v[60:63], v[188:191], v[216:219], v[60:63]
  v_mfma_f32_16x16x32_bf16 v[76:79], v[188:191], v[220:223], v[76:79]
main_kernel_sk27:
  s_waitcnt vmcnt(4)
  s_waitcnt lgkmcnt(0)
  v_mfma_f32_16x16x32_bf16 v[16:19], v[96:99], v[192:195], v[16:19]
  ds_read_b128 v[208:211], v14 offset:19456
  v_mfma_f32_16x16x32_bf16 v[32:35], v[96:99], v[196:199], v[32:35]
  ds_read_b128 v[212:215], v14 offset:39936
  v_mfma_f32_16x16x32_bf16 v[48:51], v[96:99], v[200:203], v[48:51]
  ds_read_b128 v[216:219], v14 offset:60416
  v_mfma_f32_16x16x32_bf16 v[64:67], v[96:99], v[204:207], v[64:67]
  ds_read_b128 v[220:223], v15 offset:19456
  v_mfma_f32_16x16x32_bf16 v[20:23], v[100:103], v[192:195], v[20:23]
  v_mfma_f32_16x16x32_bf16 v[36:39], v[100:103], v[196:199], v[36:39]
  v_mfma_f32_16x16x32_bf16 v[52:55], v[100:103], v[200:203], v[52:55]
  v_mfma_f32_16x16x32_bf16 v[68:71], v[100:103], v[204:207], v[68:71]
  v_mfma_f32_16x16x32_bf16 v[24:27], v[104:107], v[192:195], v[24:27]
  v_mfma_f32_16x16x32_bf16 v[40:43], v[104:107], v[196:199], v[40:43]
  v_mfma_f32_16x16x32_bf16 v[56:59], v[104:107], v[200:203], v[56:59]
  v_mfma_f32_16x16x32_bf16 v[72:75], v[104:107], v[204:207], v[72:75]
  s_cbranch_vccz main_kernel_sk28
  v_mfma_f32_16x16x32_bf16 v[28:31], v[108:111], v[192:195], v[28:31]
  v_mfma_f32_16x16x32_bf16 v[44:47], v[108:111], v[196:199], v[44:47]
  v_mfma_f32_16x16x32_bf16 v[60:63], v[108:111], v[200:203], v[60:63]
  v_mfma_f32_16x16x32_bf16 v[76:79], v[108:111], v[204:207], v[76:79]
main_kernel_sk28:
  s_waitcnt vmcnt(0)
  s_waitcnt lgkmcnt(0)
  v_mfma_f32_16x16x32_bf16 v[16:19], v[112:115], v[208:211], v[16:19]
  v_mfma_f32_16x16x32_bf16 v[32:35], v[112:115], v[212:215], v[32:35]
  v_mfma_f32_16x16x32_bf16 v[48:51], v[112:115], v[216:219], v[48:51]
  v_mfma_f32_16x16x32_bf16 v[64:67], v[112:115], v[220:223], v[64:67]
  v_mfma_f32_16x16x32_bf16 v[20:23], v[116:119], v[208:211], v[20:23]
  v_mfma_f32_16x16x32_bf16 v[36:39], v[116:119], v[212:215], v[36:39]
  v_mfma_f32_16x16x32_bf16 v[52:55], v[116:119], v[216:219], v[52:55]
  v_mfma_f32_16x16x32_bf16 v[68:71], v[116:119], v[220:223], v[68:71]
  v_mfma_f32_16x16x32_bf16 v[24:27], v[120:123], v[208:211], v[24:27]
  v_mfma_f32_16x16x32_bf16 v[40:43], v[120:123], v[212:215], v[40:43]
  v_mfma_f32_16x16x32_bf16 v[56:59], v[120:123], v[216:219], v[56:59]
  v_mfma_f32_16x16x32_bf16 v[72:75], v[120:123], v[220:223], v[72:75]
  s_cbranch_vccz main_kernel_sk29
  v_mfma_f32_16x16x32_bf16 v[28:31], v[124:127], v[208:211], v[28:31]
  v_mfma_f32_16x16x32_bf16 v[44:47], v[124:127], v[212:215], v[44:47]
  v_mfma_f32_16x16x32_bf16 v[60:63], v[124:127], v[216:219], v[60:63]
  v_mfma_f32_16x16x32_bf16 v[76:79], v[124:127], v[220:223], v[76:79]
main_kernel_sk29:
  s_setprio 0
  s_mov_b32 s91, s45
  s_mul_i32 s45, s41, 5
  s_setprio 2
  s_add_u32 s72, s4, 18268160
  s_addc_u32 s73, s5, 0
  s_mov_b32 s74, 7077888
  s_mov_b32 s75, 0x20000
  s_mul_i32 s88, s41, 7
  s_sub_u32 s88, s88, s95
  s_lshl_b32 s46, s3, 1
  s_cmp_eq_u32 s3, 3
  s_cselect_b32 s46, 5, s46
  s_cmp_ge_u32 s41, 6
  s_cselect_b32 s46, s3, s46
  s_add_u32 s89, s88, s46
  s_lshl_b32 s89, s89, 10
  s_lshr_b32 s46, s3, 1
  s_add_u32 s46, s46, 4
  s_cmp_ge_u32 s41, 6
  s_cselect_b32 s46, s46, 6
  s_add_u32 s90, s88, s46
  s_lshl_b32 s90, s90, 10
  s_and_b32 s46, s3, 1
  s_lshl_b32 s46, s46, 9
  s_add_u32 s90, s90, s46
  v_mov_b32 v208, 1.0
  v_mov_b32 v209, 1.0
  s_waitcnt lgkmcnt(0)
  v_pk_fma_f32 v[16:17], v[224:225], v[128:129], v[16:17] op_sel:[0,0,0] op_sel_hi:[0,1,1]
  v_pk_fma_f32 v[18:19], v[224:225], v[130:131], v[18:19] op_sel:[0,0,0] op_sel_hi:[0,1,1]
  v_pk_fma_f32 v[20:21], v[224:225], v[132:133], v[20:21] op_sel:[0,0,0] op_sel_hi:[0,1,1]
  v_pk_fma_f32 v[22:23], v[224:225], v[134:135], v[22:23] op_sel:[0,0,0] op_sel_hi:[0,1,1]
  v_pk_fma_f32 v[24:25], v[224:225], v[136:137], v[24:25] op_sel:[0,0,0] op_sel_hi:[0,1,1]
  v_pk_fma_f32 v[26:27], v[224:225], v[138:139], v[26:27] op_sel:[0,0,0] op_sel_hi:[0,1,1]
  v_pk_fma_f32 v[28:29], v[224:225], v[140:141], v[28:29] op_sel:[0,0,0] op_sel_hi:[0,1,1]
  v_pk_fma_f32 v[30:31], v[224:225], v[142:143], v[30:31] op_sel:[0,0,0] op_sel_hi:[0,1,1]
  v_pk_mul_f32 v[192:193], v[16:17], v[16:17]
  v_pk_mul_f32 v[194:195], v[18:19], v[18:19]
  v_pk_mul_f32 v[196:197], v[20:21], v[20:21]
  v_pk_mul_f32 v[198:199], v[22:23], v[22:23]
  v_pk_mul_f32 v[200:201], v[24:25], v[24:25]
  v_pk_mul_f32 v[202:203], v[26:27], v[26:27]
  v_pk_mul_f32 v[204:205], v[28:29], v[28:29]
  v_pk_mul_f32 v[206:207], v[30:31], v[30:31]
  v_pk_fma_f32 v[192:193], v[192:193], v[224:225], v[226:227] op_sel:[0,1,0] op_sel_hi:[1,1,0]
  v_pk_fma_f32 v[194:195], v[194:195], v[224:225], v[226:227] op_sel:[0,1,0] op_sel_hi:[1,1,0]
  v_pk_fma_f32 v[196:197], v[196:197], v[224:225], v[226:227] op_sel:[0,1,0] op_sel_hi:[1,1,0]
  v_pk_fma_f32 v[198:199], v[198:199], v[224:225], v[226:227] op_sel:[0,1,0] op_sel_hi:[1,1,0]
  v_pk_fma_f32 v[200:201], v[200:201], v[224:225], v[226:227] op_sel:[0,1,0] op_sel_hi:[1,1,0]
  v_pk_fma_f32 v[202:203], v[202:203], v[224:225], v[226:227] op_sel:[0,1,0] op_sel_hi:[1,1,0]
  v_pk_fma_f32 v[204:205], v[204:205], v[224:225], v[226:227] op_sel:[0,1,0] op_sel_hi:[1,1,0]
  v_pk_fma_f32 v[206:207], v[206:207], v[224:225], v[226:227] op_sel:[0,1,0] op_sel_hi:[1,1,0]
  v_pk_mul_f32 v[192:193], v[192:193], v[16:17]
  v_pk_mul_f32 v[194:195], v[194:195], v[18:19]
  v_pk_mul_f32 v[196:197], v[196:197], v[20:21]
  v_pk_mul_f32 v[198:199], v[198:199], v[22:23]
  v_pk_mul_f32 v[200:201], v[200:201], v[24:25]
  v_pk_mul_f32 v[202:203], v[202:203], v[26:27]
  v_pk_mul_f32 v[204:205], v[204:205], v[28:29]
  v_pk_mul_f32 v[206:207], v[206:207], v[30:31]
  v_exp_f32 v192, v192
  v_exp_f32 v193, v193
  v_exp_f32 v194, v194
  v_exp_f32 v195, v195
  v_exp_f32 v196, v196
  v_exp_f32 v197, v197
  v_exp_f32 v198, v198
  v_exp_f32 v199, v199
  v_exp_f32 v200, v200
  v_exp_f32 v201, v201
  v_exp_f32 v202, v202
  v_exp_f32 v203, v203
  v_exp_f32 v204, v204
  v_exp_f32 v205, v205
  v_exp_f32 v206, v206
  v_exp_f32 v207, v207
  v_pk_mul_f32 v[16:17], v[16:17], v[226:227] op_sel:[0,1] op_sel_hi:[1,1]
  v_pk_mul_f32 v[18:19], v[18:19], v[226:227] op_sel:[0,1] op_sel_hi:[1,1]
  v_pk_mul_f32 v[20:21], v[20:21], v[226:227] op_sel:[0,1] op_sel_hi:[1,1]
  v_pk_mul_f32 v[22:23], v[22:23], v[226:227] op_sel:[0,1] op_sel_hi:[1,1]
  v_pk_mul_f32 v[24:25], v[24:25], v[226:227] op_sel:[0,1] op_sel_hi:[1,1]
  v_pk_mul_f32 v[26:27], v[26:27], v[226:227] op_sel:[0,1] op_sel_hi:[1,1]
  v_pk_mul_f32 v[28:29], v[28:29], v[226:227] op_sel:[0,1] op_sel_hi:[1,1]
  v_pk_mul_f32 v[30:31], v[30:31], v[226:227] op_sel:[0,1] op_sel_hi:[1,1]
  v_pk_add_f32 v[192:193], v[192:193], v[208:209]
  v_pk_add_f32 v[194:195], v[194:195], v[208:209]
  v_pk_add_f32 v[196:197], v[196:197], v[208:209]
  v_pk_add_f32 v[198:199], v[198:199], v[208:209]
  v_pk_add_f32 v[200:201], v[200:201], v[208:209]
  v_pk_add_f32 v[202:203], v[202:203], v[208:209]
  v_pk_add_f32 v[204:205], v[204:205], v[208:209]
  v_pk_add_f32 v[206:207], v[206:207], v[208:209]
  v_rcp_f32 v192, v192
  v_rcp_f32 v193, v193
  v_rcp_f32 v194, v194
  v_rcp_f32 v195, v195
  v_rcp_f32 v196, v196
  v_rcp_f32 v197, v197
  v_rcp_f32 v198, v198
  v_rcp_f32 v199, v199
  v_rcp_f32 v200, v200
  v_rcp_f32 v201, v201
  v_rcp_f32 v202, v202
  v_rcp_f32 v203, v203
  v_rcp_f32 v204, v204
  v_rcp_f32 v205, v205
  v_rcp_f32 v206, v206
  v_rcp_f32 v207, v207
  v_pk_mul_f32 v[16:17], v[16:17], v[192:193]
  v_pk_mul_f32 v[18:19], v[18:19], v[194:195]
  v_pk_mul_f32 v[20:21], v[20:21], v[196:197]
  v_pk_mul_f32 v[22:23], v[22:23], v[198:199]
  v_pk_mul_f32 v[24:25], v[24:25], v[200:201]
  v_pk_mul_f32 v[26:27], v[26:27], v[202:203]
  v_pk_mul_f32 v[28:29], v[28:29], v[204:205]
  v_pk_mul_f32 v[30:31], v[30:31], v[206:207]
  v_cvt_pk_bf16_f32 v212, v16, v17
  v_cvt_pk_bf16_f32 v213, v18, v19
  v_cvt_pk_bf16_f32 v214, v20, v21
  v_cvt_pk_bf16_f32 v215, v22, v23
  v_cvt_pk_bf16_f32 v216, v24, v25
  v_cvt_pk_bf16_f32 v217, v26, v27
  v_cvt_pk_bf16_f32 v218, v28, v29
  v_cvt_pk_bf16_f32 v219, v30, v31
  s_lshl_b32 s46, s40, 2
  s_add_u32 s46, s46, 0
  s_mul_i32 s46, s46, 55296
  v_add_u32 v12, s46, v3
  buffer_store_dwordx4 v[212:215], v12, s[72:75], s89 offen sc1
  s_cbranch_vccz main_kernel_c330
  buffer_store_dwordx4 v[216:219], v12, s[72:75], s89 offen offset:1024 sc1
  s_branch main_kernel_ce31
main_kernel_c330:
  s_nop 0
  v_mov_b32 v218, v216
  v_mov_b32 v219, v217
  v_mov_b32 v13, 2130706432
  v_cndmask_b32 v13, v13, v12, s[38:39]
  v_permlane32_swap_b32 v216, v218
  v_permlane32_swap_b32 v217, v219
  buffer_store_dwordx4 v[216:219], v13, s[72:75], s90 offen sc1
main_kernel_ce31:
  s_nop 1
  v_pk_fma_f32 v[32:33], v[228:229], v[128:129], v[32:33] op_sel:[0,0,0] op_sel_hi:[0,1,1]
  v_pk_fma_f32 v[34:35], v[228:229], v[130:131], v[34:35] op_sel:[0,0,0] op_sel_hi:[0,1,1]
  v_pk_fma_f32 v[36:37], v[228:229], v[132:133], v[36:37] op_sel:[0,0,0] op_sel_hi:[0,1,1]
  v_pk_fma_f32 v[38:39], v[228:229], v[134:135], v[38:39] op_sel:[0,0,0] op_sel_hi:[0,1,1]
  v_pk_fma_f32 v[40:41], v[228:229], v[136:137], v[40:41] op_sel:[0,0,0] op_sel_hi:[0,1,1]
  v_pk_fma_f32 v[42:43], v[228:229], v[138:139], v[42:43] op_sel:[0,0,0] op_sel_hi:[0,1,1]
  v_pk_fma_f32 v[44:45], v[228:229], v[140:141], v[44:45] op_sel:[0,0,0] op_sel_hi:[0,1,1]
  v_pk_fma_f32 v[46:47], v[228:229], v[142:143], v[46:47] op_sel:[0,0,0] op_sel_hi:[0,1,1]
  v_pk_mul_f32 v[192:193], v[32:33], v[32:33]
  v_pk_mul_f32 v[194:195], v[34:35], v[34:35]
  v_pk_mul_f32 v[196:197], v[36:37], v[36:37]
  v_pk_mul_f32 v[198:199], v[38:39], v[38:39]
  v_pk_mul_f32 v[200:201], v[40:41], v[40:41]
  v_pk_mul_f32 v[202:203], v[42:43], v[42:43]
  v_pk_mul_f32 v[204:205], v[44:45], v[44:45]
  v_pk_mul_f32 v[206:207], v[46:47], v[46:47]
  v_pk_fma_f32 v[192:193], v[192:193], v[228:229], v[230:231] op_sel:[0,1,0] op_sel_hi:[1,1,0]
  v_pk_fma_f32 v[194:195], v[194:195], v[228:229], v[230:231] op_sel:[0,1,0] op_sel_hi:[1,1,0]
  v_pk_fma_f32 v[196:197], v[196:197], v[228:229], v[230:231] op_sel:[0,1,0] op_sel_hi:[1,1,0]
  v_pk_fma_f32 v[198:199], v[198:199], v[228:229], v[230:231] op_sel:[0,1,0] op_sel_hi:[1,1,0]
  v_pk_fma_f32 v[200:201], v[200:201], v[228:229], v[230:231] op_sel:[0,1,0] op_sel_hi:[1,1,0]
  v_pk_fma_f32 v[202:203], v[202:203], v[228:229], v[230:231] op_sel:[0,1,0] op_sel_hi:[1,1,0]
  v_pk_fma_f32 v[204:205], v[204:205], v[228:229], v[230:231] op_sel:[0,1,0] op_sel_hi:[1,1,0]
  v_pk_fma_f32 v[206:207], v[206:207], v[228:229], v[230:231] op_sel:[0,1,0] op_sel_hi:[1,1,0]
  v_pk_mul_f32 v[192:193], v[192:193], v[32:33]
  v_pk_mul_f32 v[194:195], v[194:195], v[34:35]
  v_pk_mul_f32 v[196:197], v[196:197], v[36:37]
  v_pk_mul_f32 v[198:199], v[198:199], v[38:39]
  v_pk_mul_f32 v[200:201], v[200:201], v[40:41]
  v_pk_mul_f32 v[202:203], v[202:203], v[42:43]
  v_pk_mul_f32 v[204:205], v[204:205], v[44:45]
  v_pk_mul_f32 v[206:207], v[206:207], v[46:47]
  v_exp_f32 v192, v192
  v_exp_f32 v193, v193
  v_exp_f32 v194, v194
  v_exp_f32 v195, v195
  v_exp_f32 v196, v196
  v_exp_f32 v197, v197
  v_exp_f32 v198, v198
  v_exp_f32 v199, v199
  v_exp_f32 v200, v200
  v_exp_f32 v201, v201
  v_exp_f32 v202, v202
  v_exp_f32 v203, v203
  v_exp_f32 v204, v204
  v_exp_f32 v205, v205
  v_exp_f32 v206, v206
  v_exp_f32 v207, v207
  v_pk_mul_f32 v[32:33], v[32:33], v[230:231] op_sel:[0,1] op_sel_hi:[1,1]
  v_pk_mul_f32 v[34:35], v[34:35], v[230:231] op_sel:[0,1] op_sel_hi:[1,1]
  v_pk_mul_f32 v[36:37], v[36:37], v[230:231] op_sel:[0,1] op_sel_hi:[1,1]
  v_pk_mul_f32 v[38:39], v[38:39], v[230:231] op_sel:[0,1] op_sel_hi:[1,1]
  v_pk_mul_f32 v[40:41], v[40:41], v[230:231] op_sel:[0,1] op_sel_hi:[1,1]
  v_pk_mul_f32 v[42:43], v[42:43], v[230:231] op_sel:[0,1] op_sel_hi:[1,1]
  v_pk_mul_f32 v[44:45], v[44:45], v[230:231] op_sel:[0,1] op_sel_hi:[1,1]
  v_pk_mul_f32 v[46:47], v[46:47], v[230:231] op_sel:[0,1] op_sel_hi:[1,1]
  v_pk_add_f32 v[192:193], v[192:193], v[208:209]
  v_pk_add_f32 v[194:195], v[194:195], v[208:209]
  v_pk_add_f32 v[196:197], v[196:197], v[208:209]
  v_pk_add_f32 v[198:199], v[198:199], v[208:209]
  v_pk_add_f32 v[200:201], v[200:201], v[208:209]
  v_pk_add_f32 v[202:203], v[202:203], v[208:209]
  v_pk_add_f32 v[204:205], v[204:205], v[208:209]
  v_pk_add_f32 v[206:207], v[206:207], v[208:209]
  v_rcp_f32 v192, v192
  v_rcp_f32 v193, v193
  v_rcp_f32 v194, v194
  v_rcp_f32 v195, v195
  v_rcp_f32 v196, v196
  v_rcp_f32 v197, v197
  v_rcp_f32 v198, v198
  v_rcp_f32 v199, v199
  v_rcp_f32 v200, v200
  v_rcp_f32 v201, v201
  v_rcp_f32 v202, v202
  v_rcp_f32 v203, v203
  v_rcp_f32 v204, v204
  v_rcp_f32 v205, v205
  v_rcp_f32 v206, v206
  v_rcp_f32 v207, v207
  v_pk_mul_f32 v[32:33], v[32:33], v[192:193]
  v_pk_mul_f32 v[34:35], v[34:35], v[194:195]
  v_pk_mul_f32 v[36:37], v[36:37], v[196:197]
  v_pk_mul_f32 v[38:39], v[38:39], v[198:199]
  v_pk_mul_f32 v[40:41], v[40:41], v[200:201]
  v_pk_mul_f32 v[42:43], v[42:43], v[202:203]
  v_pk_mul_f32 v[44:45], v[44:45], v[204:205]
  v_pk_mul_f32 v[46:47], v[46:47], v[206:207]
  v_cvt_pk_bf16_f32 v220, v32, v33
  v_cvt_pk_bf16_f32 v221, v34, v35
  v_cvt_pk_bf16_f32 v222, v36, v37
  v_cvt_pk_bf16_f32 v223, v38, v39
  v_cvt_pk_bf16_f32 v224, v40, v41
  v_cvt_pk_bf16_f32 v225, v42, v43
  v_cvt_pk_bf16_f32 v226, v44, v45
  v_cvt_pk_bf16_f32 v227, v46, v47
  s_lshl_b32 s46, s40, 2
  s_add_u32 s46, s46, 1
  s_mul_i32 s46, s46, 55296
  v_add_u32 v12, s46, v3
  buffer_store_dwordx4 v[220:223], v12, s[72:75], s89 offen sc1
  s_cbranch_vccz main_kernel_c332
  buffer_store_dwordx4 v[224:227], v12, s[72:75], s89 offen offset:1024 sc1
  s_branch main_kernel_ce33
main_kernel_c332:
  s_nop 0
  v_mov_b32 v226, v224
  v_mov_b32 v227, v225
  v_mov_b32 v13, 2130706432
  v_cndmask_b32 v13, v13, v12, s[38:39]
  v_permlane32_swap_b32 v224, v226
  v_permlane32_swap_b32 v225, v227
  buffer_store_dwordx4 v[224:227], v13, s[72:75], s90 offen sc1
main_kernel_ce33:
  s_nop 1
  v_pk_fma_f32 v[48:49], v[232:233], v[128:129], v[48:49] op_sel:[0,0,0] op_sel_hi:[0,1,1]
  v_pk_fma_f32 v[50:51], v[232:233], v[130:131], v[50:51] op_sel:[0,0,0] op_sel_hi:[0,1,1]
  v_pk_fma_f32 v[52:53], v[232:233], v[132:133], v[52:53] op_sel:[0,0,0] op_sel_hi:[0,1,1]
  v_pk_fma_f32 v[54:55], v[232:233], v[134:135], v[54:55] op_sel:[0,0,0] op_sel_hi:[0,1,1]
  v_pk_fma_f32 v[56:57], v[232:233], v[136:137], v[56:57] op_sel:[0,0,0] op_sel_hi:[0,1,1]
  v_pk_fma_f32 v[58:59], v[232:233], v[138:139], v[58:59] op_sel:[0,0,0] op_sel_hi:[0,1,1]
  v_pk_fma_f32 v[60:61], v[232:233], v[140:141], v[60:61] op_sel:[0,0,0] op_sel_hi:[0,1,1]
  v_pk_fma_f32 v[62:63], v[232:233], v[142:143], v[62:63] op_sel:[0,0,0] op_sel_hi:[0,1,1]
  v_pk_mul_f32 v[192:193], v[48:49], v[48:49]
  v_pk_mul_f32 v[194:195], v[50:51], v[50:51]
  v_pk_mul_f32 v[196:197], v[52:53], v[52:53]
  v_pk_mul_f32 v[198:199], v[54:55], v[54:55]
  v_pk_mul_f32 v[200:201], v[56:57], v[56:57]
  v_pk_mul_f32 v[202:203], v[58:59], v[58:59]
  v_pk_mul_f32 v[204:205], v[60:61], v[60:61]
  v_pk_mul_f32 v[206:207], v[62:63], v[62:63]
  v_pk_fma_f32 v[192:193], v[192:193], v[232:233], v[234:235] op_sel:[0,1,0] op_sel_hi:[1,1,0]
  v_pk_fma_f32 v[194:195], v[194:195], v[232:233], v[234:235] op_sel:[0,1,0] op_sel_hi:[1,1,0]
  v_pk_fma_f32 v[196:197], v[196:197], v[232:233], v[234:235] op_sel:[0,1,0] op_sel_hi:[1,1,0]
  v_pk_fma_f32 v[198:199], v[198:199], v[232:233], v[234:235] op_sel:[0,1,0] op_sel_hi:[1,1,0]
  v_pk_fma_f32 v[200:201], v[200:201], v[232:233], v[234:235] op_sel:[0,1,0] op_sel_hi:[1,1,0]
  v_pk_fma_f32 v[202:203], v[202:203], v[232:233], v[234:235] op_sel:[0,1,0] op_sel_hi:[1,1,0]
  v_pk_fma_f32 v[204:205], v[204:205], v[232:233], v[234:235] op_sel:[0,1,0] op_sel_hi:[1,1,0]
  v_pk_fma_f32 v[206:207], v[206:207], v[232:233], v[234:235] op_sel:[0,1,0] op_sel_hi:[1,1,0]
  v_pk_mul_f32 v[192:193], v[192:193], v[48:49]
  v_pk_mul_f32 v[194:195], v[194:195], v[50:51]
  v_pk_mul_f32 v[196:197], v[196:197], v[52:53]
  v_pk_mul_f32 v[198:199], v[198:199], v[54:55]
  v_pk_mul_f32 v[200:201], v[200:201], v[56:57]
  v_pk_mul_f32 v[202:203], v[202:203], v[58:59]
  v_pk_mul_f32 v[204:205], v[204:205], v[60:61]
  v_pk_mul_f32 v[206:207], v[206:207], v[62:63]
  v_exp_f32 v192, v192
  v_exp_f32 v193, v193
  v_exp_f32 v194, v194
  v_exp_f32 v195, v195
  v_exp_f32 v196, v196
  v_exp_f32 v197, v197
  v_exp_f32 v198, v198
  v_exp_f32 v199, v199
  v_exp_f32 v200, v200
  v_exp_f32 v201, v201
  v_exp_f32 v202, v202
  v_exp_f32 v203, v203
  v_exp_f32 v204, v204
  v_exp_f32 v205, v205
  v_exp_f32 v206, v206
  v_exp_f32 v207, v207
  v_pk_mul_f32 v[48:49], v[48:49], v[234:235] op_sel:[0,1] op_sel_hi:[1,1]
  v_pk_mul_f32 v[50:51], v[50:51], v[234:235] op_sel:[0,1] op_sel_hi:[1,1]
  v_pk_mul_f32 v[52:53], v[52:53], v[234:235] op_sel:[0,1] op_sel_hi:[1,1]
  v_pk_mul_f32 v[54:55], v[54:55], v[234:235] op_sel:[0,1] op_sel_hi:[1,1]
  v_pk_mul_f32 v[56:57], v[56:57], v[234:235] op_sel:[0,1] op_sel_hi:[1,1]
  v_pk_mul_f32 v[58:59], v[58:59], v[234:235] op_sel:[0,1] op_sel_hi:[1,1]
  v_pk_mul_f32 v[60:61], v[60:61], v[234:235] op_sel:[0,1] op_sel_hi:[1,1]
  v_pk_mul_f32 v[62:63], v[62:63], v[234:235] op_sel:[0,1] op_sel_hi:[1,1]
  v_pk_add_f32 v[192:193], v[192:193], v[208:209]
  v_pk_add_f32 v[194:195], v[194:195], v[208:209]
  v_pk_add_f32 v[196:197], v[196:197], v[208:209]
  v_pk_add_f32 v[198:199], v[198:199], v[208:209]
  v_pk_add_f32 v[200:201], v[200:201], v[208:209]
  v_pk_add_f32 v[202:203], v[202:203], v[208:209]
  v_pk_add_f32 v[204:205], v[204:205], v[208:209]
  v_pk_add_f32 v[206:207], v[206:207], v[208:209]
  v_rcp_f32 v192, v192
  v_rcp_f32 v193, v193
  v_rcp_f32 v194, v194
  v_rcp_f32 v195, v195
  v_rcp_f32 v196, v196
  v_rcp_f32 v197, v197
  v_rcp_f32 v198, v198
  v_rcp_f32 v199, v199
  v_rcp_f32 v200, v200
  v_rcp_f32 v201, v201
  v_rcp_f32 v202, v202
  v_rcp_f32 v203, v203
  v_rcp_f32 v204, v204
  v_rcp_f32 v205, v205
  v_rcp_f32 v206, v206
  v_rcp_f32 v207, v207
  v_pk_mul_f32 v[48:49], v[48:49], v[192:193]
  v_pk_mul_f32 v[50:51], v[50:51], v[194:195]
  v_pk_mul_f32 v[52:53], v[52:53], v[196:197]
  v_pk_mul_f32 v[54:55], v[54:55], v[198:199]
  v_pk_mul_f32 v[56:57], v[56:57], v[200:201]
  v_pk_mul_f32 v[58:59], v[58:59], v[202:203]
  v_pk_mul_f32 v[60:61], v[60:61], v[204:205]
  v_pk_mul_f32 v[62:63], v[62:63], v[206:207]
  v_cvt_pk_bf16_f32 v212, v48, v49
  v_cvt_pk_bf16_f32 v213, v50, v51
  v_cvt_pk_bf16_f32 v214, v52, v53
  v_cvt_pk_bf16_f32 v215, v54, v55
  v_cvt_pk_bf16_f32 v216, v56, v57
  v_cvt_pk_bf16_f32 v217, v58, v59
  v_cvt_pk_bf16_f32 v218, v60, v61
  v_cvt_pk_bf16_f32 v219, v62, v63
  s_lshl_b32 s46, s40, 2
  s_add_u32 s46, s46, 2
  s_mul_i32 s46, s46, 55296
  v_add_u32 v12, s46, v3
  buffer_store_dwordx4 v[212:215], v12, s[72:75], s89 offen sc1
  s_cbranch_vccz main_kernel_c334
  buffer_store_dwordx4 v[216:219], v12, s[72:75], s89 offen offset:1024 sc1
  s_branch main_kernel_ce35
main_kernel_c334:
  s_nop 0
  v_mov_b32 v218, v216
  v_mov_b32 v219, v217
  v_mov_b32 v13, 2130706432
  v_cndmask_b32 v13, v13, v12, s[38:39]
  v_permlane32_swap_b32 v216, v218
  v_permlane32_swap_b32 v217, v219
  buffer_store_dwordx4 v[216:219], v13, s[72:75], s90 offen sc1
main_kernel_ce35:
  s_nop 1
  v_pk_fma_f32 v[64:65], v[236:237], v[128:129], v[64:65] op_sel:[0,0,0] op_sel_hi:[0,1,1]
  v_pk_fma_f32 v[66:67], v[236:237], v[130:131], v[66:67] op_sel:[0,0,0] op_sel_hi:[0,1,1]
  v_pk_fma_f32 v[68:69], v[236:237], v[132:133], v[68:69] op_sel:[0,0,0] op_sel_hi:[0,1,1]
  v_pk_fma_f32 v[70:71], v[236:237], v[134:135], v[70:71] op_sel:[0,0,0] op_sel_hi:[0,1,1]
  v_pk_fma_f32 v[72:73], v[236:237], v[136:137], v[72:73] op_sel:[0,0,0] op_sel_hi:[0,1,1]
  v_pk_fma_f32 v[74:75], v[236:237], v[138:139], v[74:75] op_sel:[0,0,0] op_sel_hi:[0,1,1]
  v_pk_fma_f32 v[76:77], v[236:237], v[140:141], v[76:77] op_sel:[0,0,0] op_sel_hi:[0,1,1]
  v_pk_fma_f32 v[78:79], v[236:237], v[142:143], v[78:79] op_sel:[0,0,0] op_sel_hi:[0,1,1]
  v_pk_mul_f32 v[192:193], v[64:65], v[64:65]
  v_pk_mul_f32 v[194:195], v[66:67], v[66:67]
  v_pk_mul_f32 v[196:197], v[68:69], v[68:69]
  v_pk_mul_f32 v[198:199], v[70:71], v[70:71]
  v_pk_mul_f32 v[200:201], v[72:73], v[72:73]
  v_pk_mul_f32 v[202:203], v[74:75], v[74:75]
  v_pk_mul_f32 v[204:205], v[76:77], v[76:77]
  v_pk_mul_f32 v[206:207], v[78:79], v[78:79]
  v_pk_fma_f32 v[192:193], v[192:193], v[236:237], v[238:239] op_sel:[0,1,0] op_sel_hi:[1,1,0]
  v_pk_fma_f32 v[194:195], v[194:195], v[236:237], v[238:239] op_sel:[0,1,0] op_sel_hi:[1,1,0]
  v_pk_fma_f32 v[196:197], v[196:197], v[236:237], v[238:239] op_sel:[0,1,0] op_sel_hi:[1,1,0]
  v_pk_fma_f32 v[198:199], v[198:199], v[236:237], v[238:239] op_sel:[0,1,0] op_sel_hi:[1,1,0]
  v_pk_fma_f32 v[200:201], v[200:201], v[236:237], v[238:239] op_sel:[0,1,0] op_sel_hi:[1,1,0]
  v_pk_fma_f32 v[202:203], v[202:203], v[236:237], v[238:239] op_sel:[0,1,0] op_sel_hi:[1,1,0]
  v_pk_fma_f32 v[204:205], v[204:205], v[236:237], v[238:239] op_sel:[0,1,0] op_sel_hi:[1,1,0]
  v_pk_fma_f32 v[206:207], v[206:207], v[236:237], v[238:239] op_sel:[0,1,0] op_sel_hi:[1,1,0]
  v_pk_mul_f32 v[192:193], v[192:193], v[64:65]
  v_pk_mul_f32 v[194:195], v[194:195], v[66:67]
  v_pk_mul_f32 v[196:197], v[196:197], v[68:69]
  v_pk_mul_f32 v[198:199], v[198:199], v[70:71]
  v_pk_mul_f32 v[200:201], v[200:201], v[72:73]
  v_pk_mul_f32 v[202:203], v[202:203], v[74:75]
  v_pk_mul_f32 v[204:205], v[204:205], v[76:77]
  v_pk_mul_f32 v[206:207], v[206:207], v[78:79]
  v_exp_f32 v192, v192
  v_exp_f32 v193, v193
  v_exp_f32 v194, v194
  v_exp_f32 v195, v195
  v_exp_f32 v196, v196
  v_exp_f32 v197, v197
  v_exp_f32 v198, v198
  v_exp_f32 v199, v199
  v_exp_f32 v200, v200
  v_exp_f32 v201, v201
  v_exp_f32 v202, v202
  v_exp_f32 v203, v203
  v_exp_f32 v204, v204
  v_exp_f32 v205, v205
  v_exp_f32 v206, v206
  v_exp_f32 v207, v207
  v_pk_mul_f32 v[64:65], v[64:65], v[238:239] op_sel:[0,1] op_sel_hi:[1,1]
  v_pk_mul_f32 v[66:67], v[66:67], v[238:239] op_sel:[0,1] op_sel_hi:[1,1]
  v_pk_mul_f32 v[68:69], v[68:69], v[238:239] op_sel:[0,1] op_sel_hi:[1,1]
  v_pk_mul_f32 v[70:71], v[70:71], v[238:239] op_sel:[0,1] op_sel_hi:[1,1]
  v_pk_mul_f32 v[72:73], v[72:73], v[238:239] op_sel:[0,1] op_sel_hi:[1,1]
  v_pk_mul_f32 v[74:75], v[74:75], v[238:239] op_sel:[0,1] op_sel_hi:[1,1]
  v_pk_mul_f32 v[76:77], v[76:77], v[238:239] op_sel:[0,1] op_sel_hi:[1,1]
  v_pk_mul_f32 v[78:79], v[78:79], v[238:239] op_sel:[0,1] op_sel_hi:[1,1]
  v_pk_add_f32 v[192:193], v[192:193], v[208:209]
  v_pk_add_f32 v[194:195], v[194:195], v[208:209]
  v_pk_add_f32 v[196:197], v[196:197], v[208:209]
  v_pk_add_f32 v[198:199], v[198:199], v[208:209]
  v_pk_add_f32 v[200:201], v[200:201], v[208:209]
  v_pk_add_f32 v[202:203], v[202:203], v[208:209]
  v_pk_add_f32 v[204:205], v[204:205], v[208:209]
  v_pk_add_f32 v[206:207], v[206:207], v[208:209]
  v_rcp_f32 v192, v192
  v_rcp_f32 v193, v193
  v_rcp_f32 v194, v194
  v_rcp_f32 v195, v195
  v_rcp_f32 v196, v196
  v_rcp_f32 v197, v197
  v_rcp_f32 v198, v198
  v_rcp_f32 v199, v199
  v_rcp_f32 v200, v200
  v_rcp_f32 v201, v201
  v_rcp_f32 v202, v202
  v_rcp_f32 v203, v203
  v_rcp_f32 v204, v204
  v_rcp_f32 v205, v205
  v_rcp_f32 v206, v206
  v_rcp_f32 v207, v207
  v_pk_mul_f32 v[64:65], v[64:65], v[192:193]
  v_pk_mul_f32 v[66:67], v[66:67], v[194:195]
  v_pk_mul_f32 v[68:69], v[68:69], v[196:197]
  v_pk_mul_f32 v[70:71], v[70:71], v[198:199]
  v_pk_mul_f32 v[72:73], v[72:73], v[200:201]
  v_pk_mul_f32 v[74:75], v[74:75], v[202:203]
  v_pk_mul_f32 v[76:77], v[76:77], v[204:205]
  v_pk_mul_f32 v[78:79], v[78:79], v[206:207]
  v_cvt_pk_bf16_f32 v220, v64, v65
  v_cvt_pk_bf16_f32 v221, v66, v67
  v_cvt_pk_bf16_f32 v222, v68, v69
  v_cvt_pk_bf16_f32 v223, v70, v71
  v_cvt_pk_bf16_f32 v224, v72, v73
  v_cvt_pk_bf16_f32 v225, v74, v75
  v_cvt_pk_bf16_f32 v226, v76, v77
  v_cvt_pk_bf16_f32 v227, v78, v79
  s_lshl_b32 s46, s40, 2
  s_add_u32 s46, s46, 3
  s_mul_i32 s46, s46, 55296
  v_add_u32 v12, s46, v3
  buffer_store_dwordx4 v[220:223], v12, s[72:75], s89 offen sc1
  s_cbranch_vccz main_kernel_c336
  buffer_store_dwordx4 v[224:227], v12, s[72:75], s89 offen offset:1024 sc1
  s_branch main_kernel_ce37
main_kernel_c336:
  s_nop 0
  v_mov_b32 v226, v224
  v_mov_b32 v227, v225
  v_mov_b32 v13, 2130706432
  v_cndmask_b32 v13, v13, v12, s[38:39]
  v_permlane32_swap_b32 v224, v226
  v_permlane32_swap_b32 v225, v227
  buffer_store_dwordx4 v[224:227], v13, s[72:75], s90 offen sc1
main_kernel_ce37:
  s_nop 1
  s_setprio 0
  s_waitcnt vmcnt(0)
  s_barrier
  s_cmp_lg_u32 s3, 0
  s_cbranch_scc1 main_kernel_pub38
  s_lshl_b32 s46, s40, 3
  s_add_u32 s46, s46, s41
  s_lshl_b32 s46, s46, 2
  s_add_u32 s46, s46, 1024
  v_mov_b32 v252, 0
  v_mov_b32 v253, 1
  s_mov_b64 s[34:35], exec
  s_mov_b64 exec, 1
  buffer_store_dword v253, v252, s[28:31], s46 offen sc1
  s_mov_b64 exec, s[34:35]
main_kernel_pub38:
  s_add_u32 s52, s4, 5488640
  s_addc_u32 s53, s5, 0
  s_mov_b32 s54, 2211840
  s_mov_b32 s55, 0x20000
  s_mul_i32 s46, s45, 55296
  v_add_u32 v5, s46, v3
  v_add_u32 v6, 55296, v5
  v_add_u32 v7, 110592, v5
  v_add_u32 v9, 165888, v5
  v_add_u32 v14, 221184, v5
  s_lshl_b32 s58, s3, 10
  s_add_u32 s48, s4, 18268160
  s_addc_u32 s49, s5, 0
  s_mov_b32 s50, 7077888
  s_mov_b32 s51, 0x20000
  s_add_u32 s46, s3, 0
  s_and_b32 s46, s46, 3
  s_lshl_b32 s47, s40, 2
  s_add_u32 s46, s46, s47
  s_mul_i32 s46, s46, 55296
  v_add_u32 v10, s46, v3
  s_add_u32 s46, s3, 1
  s_and_b32 s46, s46, 3
  s_lshl_b32 s47, s40, 2
  s_add_u32 s46, s46, s47
  s_mul_i32 s46, s46, 55296
  v_add_u32 v11, s46, v3
  s_add_u32 s46, s3, 2
  s_and_b32 s46, s46, 3
  s_lshl_b32 s47, s40, 2
  s_add_u32 s46, s46, s47
  s_mul_i32 s46, s46, 55296
  v_add_u32 v12, s46, v3
  s_add_u32 s46, s3, 3
  s_and_b32 s46, s46, 3
  s_lshl_b32 s47, s40, 2
  s_add_u32 s46, s46, s47
  s_mul_i32 s46, s46, 55296
  v_add_u32 v13, s46, v3
  s_add_u32 s59, s58, 0
  buffer_load_dwordx4 v[96:99], v5, s[52:55], s59 offen
  buffer_load_dwordx4 v[100:103], v6, s[52:55], s59 offen
  buffer_load_dwordx4 v[104:107], v7, s[52:55], s59 offen
  buffer_load_dwordx4 v[108:111], v9, s[52:55], s59 offen
  buffer_load_dwordx4 v[112:115], v14, s[52:55], s59 offen
  s_add_u32 s59, s58, 4096
  buffer_load_dwordx4 v[116:119], v5, s[52:55], s59 offen
  buffer_load_dwordx4 v[120:123], v6, s[52:55], s59 offen
  buffer_load_dwordx4 v[124:127], v7, s[52:55], s59 offen
  buffer_load_dwordx4 v[144:147], v9, s[52:55], s59 offen
  buffer_load_dwordx4 v[148:151], v14, s[52:55], s59 offen
  s_add_u32 s59, s58, 8192
  buffer_load_dwordx4 v[152:155], v5, s[52:55], s59 offen
  buffer_load_dwordx4 v[156:159], v6, s[52:55], s59 offen
  buffer_load_dwordx4 v[160:163], v7, s[52:55], s59 offen
  buffer_load_dwordx4 v[164:167], v9, s[52:55], s59 offen
  buffer_load_dwordx4 v[168:171], v14, s[52:55], s59 offen
  s_add_u32 s59, s58, 12288
  buffer_load_dwordx4 v[172:175], v5, s[52:55], s59 offen
  buffer_load_dwordx4 v[176:179], v6, s[52:55], s59 offen
  buffer_load_dwordx4 v[180:183], v7, s[52:55], s59 offen
  buffer_load_dwordx4 v[184:187], v9, s[52:55], s59 offen
  buffer_load_dwordx4 v[188:191], v14, s[52:55], s59 offen
  s_add_u32 s64, s4, 2457600
  s_addc_u32 s65, s5, 0
  s_mov_b32 s66, 819200
  s_mov_b32 s67, 0x20000
  s_mul_i32 s46, s45, 20480
  v_add_u32 v204, s46, v3
  v_add_u32 v205, 20480, v204
  v_add_u32 v206, 40960, v204
  v_add_u32 v207, 61440, v204
  v_add_u32 v208, 81920, v204
  s_mul_i32 s63, s3, 20480
  s_lshl_b32 s33, s3, 10
  s_add_u32 m0, s63, 0
  s_nop 0
  buffer_load_dwordx4 v204, s[64:67], s33 offen lds
  s_add_u32 m0, s63, 1024
  s_nop 0
  buffer_load_dwordx4 v205, s[64:67], s33 offen lds
  s_add_u32 m0, s63, 2048
  s_nop 0
  buffer_load_dwordx4 v206, s[64:67], s33 offen lds
  s_add_u32 m0, s63, 3072
  s_nop 0
  buffer_load_dwordx4 v207, s[64:67], s33 offen lds
  s_add_u32 m0, s63, 4096
  s_nop 0
  buffer_load_dwordx4 v208, s[64:67], s33 offen lds
  s_add_u32 s33, s33, 4096
  s_add_u32 m0, s63, 5120
  s_nop 0
  buffer_load_dwordx4 v204, s[64:67], s33 offen lds
  s_add_u32 m0, s63, 6144
  s_nop 0
  buffer_load_dwordx4 v205, s[64:67], s33 offen lds
  s_add_u32 m0, s63, 7168
  s_nop 0
  buffer_load_dwordx4 v206, s[64:67], s33 offen lds
  s_add_u32 m0, s63, 8192
  s_nop 0
  buffer_load_dwordx4 v207, s[64:67], s33 offen lds
  s_add_u32 m0, s63, 9216
  s_nop 0
  buffer_load_dwordx4 v208, s[64:67], s33 offen lds
  s_add_u32 s33, s33, 4096
  s_add_u32 m0, s63, 10240
  s_nop 0
  buffer_load_dwordx4 v204, s[64:67], s33 offen lds
  s_add_u32 m0, s63, 11264
  s_nop 0
  buffer_load_dwordx4 v205, s[64:67], s33 offen lds
  s_add_u32 m0, s63, 12288
  s_nop 0
  buffer_load_dwordx4 v206, s[64:67], s33 offen lds
  s_add_u32 m0, s63, 13312
  s_nop 0
  buffer_load_dwordx4 v207, s[64:67], s33 offen lds
  s_add_u32 m0, s63, 14336
  s_nop 0
  buffer_load_dwordx4 v208, s[64:67], s33 offen lds
  s_add_u32 s33, s33, 4096
  s_add_u32 m0, s63, 15360
  s_nop 0
  buffer_load_dwordx4 v204, s[64:67], s33 offen lds
  s_add_u32 m0, s63, 16384
  s_nop 0
  buffer_load_dwordx4 v205, s[64:67], s33 offen lds
  s_add_u32 m0, s63, 17408
  s_nop 0
  buffer_load_dwordx4 v206, s[64:67], s33 offen lds
  s_add_u32 m0, s63, 18432
  s_nop 0
  buffer_load_dwordx4 v207, s[64:67], s33 offen lds
  s_add_u32 m0, s63, 19456
  s_nop 0
  buffer_load_dwordx4 v208, s[64:67], s33 offen lds
  s_add_u32 s33, s33, 4096
  s_lshl_b32 s46, s40, 5
  s_add_u32 s46, s46, 1024
  v_and_b32 v4, 7, v2
  v_lshlrev_b32 v4, 2, v4
  s_mov_b32 s47, 400000
main_kernel_poll39:
  buffer_load_dword v253, v4, s[28:31], s46 offen sc1
  s_waitcnt vmcnt(0)
  v_cmp_ne_u32 vcc, 1, v253
  s_cmp_eq_u64 vcc, 0
  s_cbranch_scc1 main_kernel_pdone40
  s_sub_u32 s47, s47, 1
  s_cmp_lg_u32 s47, 0
  s_cbranch_scc1 main_kernel_poll39
main_kernel_pdone40:
  s_add_u32 s59, s58, 0
  buffer_load_dwordx4 v[192:195], v10, s[48:51], s59 offen sc1
  buffer_load_dwordx4 v[196:199], v11, s[48:51], s59 offen sc1
  buffer_load_dwordx4 v[200:203], v12, s[48:51], s59 offen sc1
  buffer_load_dwordx4 v[204:207], v13, s[48:51], s59 offen sc1
  s_add_u32 s59, s58, 4096
  buffer_load_dwordx4 v[208:211], v10, s[48:51], s59 offen sc1
  buffer_load_dwordx4 v[212:215], v11, s[48:51], s59 offen sc1
  buffer_load_dwordx4 v[216:219], v12, s[48:51], s59 offen sc1
  buffer_load_dwordx4 v[220:223], v13, s[48:51], s59 offen sc1
  s_add_u32 s59, s58, 8192
  buffer_load_dwordx4 v[224:227], v10, s[48:51], s59 offen sc1
  buffer_load_dwordx4 v[228:231], v11, s[48:51], s59 offen sc1
  buffer_load_dwordx4 v[232:235], v12, s[48:51], s59 offen sc1
  buffer_load_dwordx4 v[236:239], v13, s[48:51], s59 offen sc1
  s_add_u32 s59, s58, 12288
  buffer_load_dwordx4 v[128:131], v10, s[48:51], s59 offen sc1
  buffer_load_dwordx4 v[132:135], v11, s[48:51], s59 offen sc1
  buffer_load_dwordx4 v[136:139], v12, s[48:51], s59 offen sc1
  buffer_load_dwordx4 v[140:143], v13, s[48:51], s59 offen sc1
  s_setprio 1
  s_waitcnt vmcnt(12)
  s_add_u32 s59, s58, 16384
  v_mfma_f32_16x16x32_bf16 v[16:19], v[96:99], v[192:195], 0
  v_mfma_f32_16x16x32_bf16 v[36:39], v[96:99], v[196:199], 0
  v_mfma_f32_16x16x32_bf16 v[56:59], v[96:99], v[200:203], 0
  v_mfma_f32_16x16x32_bf16 v[76:79], v[96:99], v[204:207], 0
  buffer_load_dwordx4 v[96:99], v5, s[52:55], s59 offen
  v_mfma_f32_16x16x32_bf16 v[20:23], v[100:103], v[192:195], 0
  v_mfma_f32_16x16x32_bf16 v[40:43], v[100:103], v[196:199], 0
  v_mfma_f32_16x16x32_bf16 v[60:63], v[100:103], v[200:203], 0
  v_mfma_f32_16x16x32_bf16 v[80:83], v[100:103], v[204:207], 0
  buffer_load_dwordx4 v[100:103], v6, s[52:55], s59 offen
  v_mfma_f32_16x16x32_bf16 v[24:27], v[104:107], v[192:195], 0
  v_mfma_f32_16x16x32_bf16 v[44:47], v[104:107], v[196:199], 0
  v_mfma_f32_16x16x32_bf16 v[64:67], v[104:107], v[200:203], 0
  v_mfma_f32_16x16x32_bf16 v[84:87], v[104:107], v[204:207], 0
  buffer_load_dwordx4 v[104:107], v7, s[52:55], s59 offen
  v_mfma_f32_16x16x32_bf16 v[28:31], v[108:111], v[192:195], 0
  v_mfma_f32_16x16x32_bf16 v[48:51], v[108:111], v[196:199], 0
  v_mfma_f32_16x16x32_bf16 v[68:71], v[108:111], v[200:203], 0
  v_mfma_f32_16x16x32_bf16 v[88:91], v[108:111], v[204:207], 0
  buffer_load_dwordx4 v[108:111], v9, s[52:55], s59 offen
  v_mfma_f32_16x16x32_bf16 v[32:35], v[112:115], v[192:195], 0
  v_mfma_f32_16x16x32_bf16 v[52:55], v[112:115], v[196:199], 0
  v_mfma_f32_16x16x32_bf16 v[72:75], v[112:115], v[200:203], 0
  v_mfma_f32_16x16x32_bf16 v[92:95], v[112:115], v[204:207], 0
  buffer_load_dwordx4 v[112:115], v14, s[52:55], s59 offen
  buffer_load_dwordx4 v[192:195], v10, s[48:51], s59 offen sc1
  buffer_load_dwordx4 v[196:199], v11, s[48:51], s59 offen sc1
  buffer_load_dwordx4 v[200:203], v12, s[48:51], s59 offen sc1
  buffer_load_dwordx4 v[204:207], v13, s[48:51], s59 offen sc1
  s_waitcnt vmcnt(17)
  s_add_u32 s59, s58, 20480
  v_mfma_f32_16x16x32_bf16 v[16:19], v[116:119], v[208:211], v[16:19]
  v_mfma_f32_16x16x32_bf16 v[36:39], v[116:119], v[212:215], v[36:39]
  v_mfma_f32_16x16x32_bf16 v[56:59], v[116:119], v[216:219], v[56:59]
  v_mfma_f32_16x16x32_bf16 v[76:79], v[116:119], v[220:223], v[76:79]
  buffer_load_dwordx4 v[116:119], v5, s[52:55], s59 offen
  v_mfma_f32_16x16x32_bf16 v[20:23], v[120:123], v[208:211], v[20:23]
  v_mfma_f32_16x16x32_bf16 v[40:43], v[120:123], v[212:215], v[40:43]
  v_mfma_f32_16x16x32_bf16 v[60:63], v[120:123], v[216:219], v[60:63]
  v_mfma_f32_16x16x32_bf16 v[80:83], v[120:123], v[220:223], v[80:83]
  buffer_load_dwordx4 v[120:123], v6, s[52:55], s59 offen
  v_mfma_f32_16x16x32_bf16 v[24:27], v[124:127], v[208:211], v[24:27]
  v_mfma_f32_16x16x32_bf16 v[44:47], v[124:127], v[212:215], v[44:47]
  v_mfma_f32_16x16x32_bf16 v[64:67], v[124:127], v[216:219], v[64:67]
  v_mfma_f32_16x16x32_bf16 v[84:87], v[124:127], v[220:223], v[84:87]
  buffer_load_dwordx4 v[124:127], v7, s[52:55], s59 offen
  v_mfma_f32_16x16x32_bf16 v[28:31], v[144:147], v[208:211], v[28:31]
  v_mfma_f32_16x16x32_bf16 v[48:51], v[144:147], v[212:215], v[48:51]
  v_mfma_f32_16x16x32_bf16 v[68:71], v[144:147], v[216:219], v[68:71]
  v_mfma_f32_16x16x32_bf16 v[88:91], v[144:147], v[220:223], v[88:91]
  buffer_load_dwordx4 v[144:147], v9, s[52:55], s59 offen
  v_mfma_f32_16x16x32_bf16 v[32:35], v[148:151], v[208:211], v[32:35]
  v_mfma_f32_16x16x32_bf16 v[52:55], v[148:151], v[212:215], v[52:55]
  v_mfma_f32_16x16x32_bf16 v[72:75], v[148:151], v[216:219], v[72:75]
  v_mfma_f32_16x16x32_bf16 v[92:95], v[148:151], v[220:223], v[92:95]
  buffer_load_dwordx4 v[148:151], v14, s[52:55], s59 offen
  buffer_load_dwordx4 v[208:211], v10, s[48:51], s59 offen sc1
  buffer_load_dwordx4 v[212:215], v11, s[48:51], s59 offen sc1
  buffer_load_dwordx4 v[216:219], v12, s[48:51], s59 offen sc1
  buffer_load_dwordx4 v[220:223], v13, s[48:51], s59 offen sc1
  s_waitcnt vmcnt(22)
  s_add_u32 s59, s58, 24576
  v_mfma_f32_16x16x32_bf16 v[16:19], v[152:155], v[224:227], v[16:19]
  v_mfma_f32_16x16x32_bf16 v[36:39], v[152:155], v[228:231], v[36:39]
  v_mfma_f32_16x16x32_bf16 v[56:59], v[152:155], v[232:235], v[56:59]
  v_mfma_f32_16x16x32_bf16 v[76:79], v[152:155], v[236:239], v[76:79]
  buffer_load_dwordx4 v[152:155], v5, s[52:55], s59 offen
  v_mfma_f32_16x16x32_bf16 v[20:23], v[156:159], v[224:227], v[20:23]
  v_mfma_f32_16x16x32_bf16 v[40:43], v[156:159], v[228:231], v[40:43]
  v_mfma_f32_16x16x32_bf16 v[60:63], v[156:159], v[232:235], v[60:63]
  v_mfma_f32_16x16x32_bf16 v[80:83], v[156:159], v[236:239], v[80:83]
  buffer_load_dwordx4 v[156:159], v6, s[52:55], s59 offen
  v_mfma_f32_16x16x32_bf16 v[24:27], v[160:163], v[224:227], v[24:27]
  v_mfma_f32_16x16x32_bf16 v[44:47], v[160:163], v[228:231], v[44:47]
  v_mfma_f32_16x16x32_bf16 v[64:67], v[160:163], v[232:235], v[64:67]
  v_mfma_f32_16x16x32_bf16 v[84:87], v[160:163], v[236:239], v[84:87]
  buffer_load_dwordx4 v[160:163], v7, s[52:55], s59 offen
  v_mfma_f32_16x16x32_bf16 v[28:31], v[164:167], v[224:227], v[28:31]
  v_mfma_f32_16x16x32_bf16 v[48:51], v[164:167], v[228:231], v[48:51]
  v_mfma_f32_16x16x32_bf16 v[68:71], v[164:167], v[232:235], v[68:71]
  v_mfma_f32_16x16x32_bf16 v[88:91], v[164:167], v[236:239], v[88:91]
  buffer_load_dwordx4 v[164:167], v9, s[52:55], s59 offen
  v_mfma_f32_16x16x32_bf16 v[32:35], v[168:171], v[224:227], v[32:35]
  v_mfma_f32_16x16x32_bf16 v[52:55], v[168:171], v[228:231], v[52:55]
  v_mfma_f32_16x16x32_bf16 v[72:75], v[168:171], v[232:235], v[72:75]
  v_mfma_f32_16x16x32_bf16 v[92:95], v[168:171], v[236:239], v[92:95]
  buffer_load_dwordx4 v[168:171], v14, s[52:55], s59 offen
  buffer_load_dwordx4 v[224:227], v10, s[48:51], s59 offen sc1
  buffer_load_dwordx4 v[228:231], v11, s[48:51], s59 offen sc1
  buffer_load_dwordx4 v[232:235], v12, s[48:51], s59 offen sc1
  buffer_load_dwordx4 v[236:239], v13, s[48:51], s59 offen sc1
  s_waitcnt vmcnt(27)
  s_add_u32 s59, s58, 28672
  v_mfma_f32_16x16x32_bf16 v[16:19], v[172:175], v[128:131], v[16:19]
  v_mfma_f32_16x16x32_bf16 v[36:39], v[172:175], v[132:135], v[36:39]
  v_mfma_f32_16x16x32_bf16 v[56:59], v[172:175], v[136:139], v[56:59]
  v_mfma_f32_16x16x32_bf16 v[76:79], v[172:175], v[140:143], v[76:79]
  buffer_load_dwordx4 v[172:175], v5, s[52:55], s59 offen
  v_mfma_f32_16x16x32_bf16 v[20:23], v[176:179], v[128:131], v[20:23]
  v_mfma_f32_16x16x32_bf16 v[40:43], v[176:179], v[132:135], v[40:43]
  v_mfma_f32_16x16x32_bf16 v[60:63], v[176:179], v[136:139], v[60:63]
  v_mfma_f32_16x16x32_bf16 v[80:83], v[176:179], v[140:143], v[80:83]
  buffer_load_dwordx4 v[176:179], v6, s[52:55], s59 offen
  v_mfma_f32_16x16x32_bf16 v[24:27], v[180:183], v[128:131], v[24:27]
  v_mfma_f32_16x16x32_bf16 v[44:47], v[180:183], v[132:135], v[44:47]
  v_mfma_f32_16x16x32_bf16 v[64:67], v[180:183], v[136:139], v[64:67]
  v_mfma_f32_16x16x32_bf16 v[84:87], v[180:183], v[140:143], v[84:87]
  buffer_load_dwordx4 v[180:183], v7, s[52:55], s59 offen
  v_mfma_f32_16x16x32_bf16 v[28:31], v[184:187], v[128:131], v[28:31]
  v_mfma_f32_16x16x32_bf16 v[48:51], v[184:187], v[132:135], v[48:51]
  v_mfma_f32_16x16x32_bf16 v[68:71], v[184:187], v[136:139], v[68:71]
  v_mfma_f32_16x16x32_bf16 v[88:91], v[184:187], v[140:143], v[88:91]
  buffer_load_dwordx4 v[184:187], v9, s[52:55], s59 offen
  v_mfma_f32_16x16x32_bf16 v[32:35], v[188:191], v[128:131], v[32:35]
  v_mfma_f32_16x16x32_bf16 v[52:55], v[188:191], v[132:135], v[52:55]
  v_mfma_f32_16x16x32_bf16 v[72:75], v[188:191], v[136:139], v[72:75]
  v_mfma_f32_16x16x32_bf16 v[92:95], v[188:191], v[140:143], v[92:95]
  buffer_load_dwordx4 v[188:191], v14, s[52:55], s59 offen
  buffer_load_dwordx4 v[128:131], v10, s[48:51], s59 offen sc1
  buffer_load_dwordx4 v[132:135], v11, s[48:51], s59 offen sc1
  buffer_load_dwordx4 v[136:139], v12, s[48:51], s59 offen sc1
  buffer_load_dwordx4 v[140:143], v13, s[48:51], s59 offen sc1
  s_waitcnt vmcnt(27)
  s_add_u32 s59, s58, 32768
  v_mfma_f32_16x16x32_bf16 v[16:19], v[96:99], v[192:195], v[16:19]
  v_mfma_f32_16x16x32_bf16 v[36:39], v[96:99], v[196:199], v[36:39]
  v_mfma_f32_16x16x32_bf16 v[56:59], v[96:99], v[200:203], v[56:59]
  v_mfma_f32_16x16x32_bf16 v[76:79], v[96:99], v[204:207], v[76:79]
  buffer_load_dwordx4 v[96:99], v5, s[52:55], s59 offen
  v_mfma_f32_16x16x32_bf16 v[20:23], v[100:103], v[192:195], v[20:23]
  v_mfma_f32_16x16x32_bf16 v[40:43], v[100:103], v[196:199], v[40:43]
  v_mfma_f32_16x16x32_bf16 v[60:63], v[100:103], v[200:203], v[60:63]
  v_mfma_f32_16x16x32_bf16 v[80:83], v[100:103], v[204:207], v[80:83]
  buffer_load_dwordx4 v[100:103], v6, s[52:55], s59 offen
  v_mfma_f32_16x16x32_bf16 v[24:27], v[104:107], v[192:195], v[24:27]
  v_mfma_f32_16x16x32_bf16 v[44:47], v[104:107], v[196:199], v[44:47]
  v_mfma_f32_16x16x32_bf16 v[64:67], v[104:107], v[200:203], v[64:67]
  v_mfma_f32_16x16x32_bf16 v[84:87], v[104:107], v[204:207], v[84:87]
  buffer_load_dwordx4 v[104:107], v7, s[52:55], s59 offen
  v_mfma_f32_16x16x32_bf16 v[28:31], v[108:111], v[192:195], v[28:31]
  v_mfma_f32_16x16x32_bf16 v[48:51], v[108:111], v[196:199], v[48:51]
  v_mfma_f32_16x16x32_bf16 v[68:71], v[108:111], v[200:203], v[68:71]
  v_mfma_f32_16x16x32_bf16 v[88:91], v[108:111], v[204:207], v[88:91]
  buffer_load_dwordx4 v[108:111], v9, s[52:55], s59 offen
  v_mfma_f32_16x16x32_bf16 v[32:35], v[112:115], v[192:195], v[32:35]
  v_mfma_f32_16x16x32_bf16 v[52:55], v[112:115], v[196:199], v[52:55]
  v_mfma_f32_16x16x32_bf16 v[72:75], v[112:115], v[200:203], v[72:75]
  v_mfma_f32_16x16x32_bf16 v[92:95], v[112:115], v[204:207], v[92:95]
  buffer_load_dwordx4 v[112:115], v14, s[52:55], s59 offen
  buffer_load_dwordx4 v[192:195], v10, s[48:51], s59 offen sc1
  buffer_load_dwordx4 v[196:199], v11, s[48:51], s59 offen sc1
  buffer_load_dwordx4 v[200:203], v12, s[48:51], s59 offen sc1
  buffer_load_dwordx4 v[204:207], v13, s[48:51], s59 offen sc1
  s_waitcnt vmcnt(27)
  s_add_u32 s59, s58, 36864
  v_mfma_f32_16x16x32_bf16 v[16:19], v[116:119], v[208:211], v[16:19]
  v_mfma_f32_16x16x32_bf16 v[36:39], v[116:119], v[212:215], v[36:39]
  v_mfma_f32_16x16x32_bf16 v[56:59], v[116:119], v[216:219], v[56:59]
  v_mfma_f32_16x16x32_bf16 v[76:79], v[116:119], v[220:223], v[76:79]
  buffer_load_dwordx4 v[116:119], v5, s[52:55], s59 offen
  v_mfma_f32_16x16x32_bf16 v[20:23], v[120:123], v[208:211], v[20:23]
  v_mfma_f32_16x16x32_bf16 v[40:43], v[120:123], v[212:215], v[40:43]
  v_mfma_f32_16x16x32_bf16 v[60:63], v[120:123], v[216:219], v[60:63]
  v_mfma_f32_16x16x32_bf16 v[80:83], v[120:123], v[220:223], v[80:83]
  buffer_load_dwordx4 v[120:123], v6, s[52:55], s59 offen
  v_mfma_f32_16x16x32_bf16 v[24:27], v[124:127], v[208:211], v[24:27]
  v_mfma_f32_16x16x32_bf16 v[44:47], v[124:127], v[212:215], v[44:47]
  v_mfma_f32_16x16x32_bf16 v[64:67], v[124:127], v[216:219], v[64:67]
  v_mfma_f32_16x16x32_bf16 v[84:87], v[124:127], v[220:223], v[84:87]
  buffer_load_dwordx4 v[124:127], v7, s[52:55], s59 offen
  v_mfma_f32_16x16x32_bf16 v[28:31], v[144:147], v[208:211], v[28:31]
  v_mfma_f32_16x16x32_bf16 v[48:51], v[144:147], v[212:215], v[48:51]
  v_mfma_f32_16x16x32_bf16 v[68:71], v[144:147], v[216:219], v[68:71]
  v_mfma_f32_16x16x32_bf16 v[88:91], v[144:147], v[220:223], v[88:91]
  buffer_load_dwordx4 v[144:147], v9, s[52:55], s59 offen
  v_mfma_f32_16x16x32_bf16 v[32:35], v[148:151], v[208:211], v[32:35]
  v_mfma_f32_16x16x32_bf16 v[52:55], v[148:151], v[212:215], v[52:55]
  v_mfma_f32_16x16x32_bf16 v[72:75], v[148:151], v[216:219], v[72:75]
  v_mfma_f32_16x16x32_bf16 v[92:95], v[148:151], v[220:223], v[92:95]
  buffer_load_dwordx4 v[148:151], v14, s[52:55], s59 offen
  buffer_load_dwordx4 v[208:211], v10, s[48:51], s59 offen sc1
  buffer_load_dwordx4 v[212:215], v11, s[48:51], s59 offen sc1
  buffer_load_dwordx4 v[216:219], v12, s[48:51], s59 offen sc1
  buffer_load_dwordx4 v[220:223], v13, s[48:51], s59 offen sc1
  s_waitcnt vmcnt(27)
  s_add_u32 s59, s58, 40960
  v_mfma_f32_16x16x32_bf16 v[16:19], v[152:155], v[224:227], v[16:19]
  v_mfma_f32_16x16x32_bf16 v[36:39], v[152:155], v[228:231], v[36:39]
  v_mfma_f32_16x16x32_bf16 v[56:59], v[152:155], v[232:235], v[56:59]
  v_mfma_f32_16x16x32_bf16 v[76:79], v[152:155], v[236:239], v[76:79]
  buffer_load_dwordx4 v[152:155], v5, s[52:55], s59 offen
  v_mfma_f32_16x16x32_bf16 v[20:23], v[156:159], v[224:227], v[20:23]
  v_mfma_f32_16x16x32_bf16 v[40:43], v[156:159], v[228:231], v[40:43]
  v_mfma_f32_16x16x32_bf16 v[60:63], v[156:159], v[232:235], v[60:63]
  v_mfma_f32_16x16x32_bf16 v[80:83], v[156:159], v[236:239], v[80:83]
  buffer_load_dwordx4 v[156:159], v6, s[52:55], s59 offen
  v_mfma_f32_16x16x32_bf16 v[24:27], v[160:163], v[224:227], v[24:27]
  v_mfma_f32_16x16x32_bf16 v[44:47], v[160:163], v[228:231], v[44:47]
  v_mfma_f32_16x16x32_bf16 v[64:67], v[160:163], v[232:235], v[64:67]
  v_mfma_f32_16x16x32_bf16 v[84:87], v[160:163], v[236:239], v[84:87]
  buffer_load_dwordx4 v[160:163], v7, s[52:55], s59 offen
  v_mfma_f32_16x16x32_bf16 v[28:31], v[164:167], v[224:227], v[28:31]
  v_mfma_f32_16x16x32_bf16 v[48:51], v[164:167], v[228:231], v[48:51]
  v_mfma_f32_16x16x32_bf16 v[68:71], v[164:167], v[232:235], v[68:71]
  v_mfma_f32_16x16x32_bf16 v[88:91], v[164:167], v[236:239], v[88:91]
  buffer_load_dwordx4 v[164:167], v9, s[52:55], s59 offen
  v_mfma_f32_16x16x32_bf16 v[32:35], v[168:171], v[224:227], v[32:35]
  v_mfma_f32_16x16x32_bf16 v[52:55], v[168:171], v[228:231], v[52:55]
  v_mfma_f32_16x16x32_bf16 v[72:75], v[168:171], v[232:235], v[72:75]
  v_mfma_f32_16x16x32_bf16 v[92:95], v[168:171], v[236:239], v[92:95]
  buffer_load_dwordx4 v[168:171], v14, s[52:55], s59 offen
  buffer_load_dwordx4 v[224:227], v10, s[48:51], s59 offen sc1
  buffer_load_dwordx4 v[228:231], v11, s[48:51], s59 offen sc1
  buffer_load_dwordx4 v[232:235], v12, s[48:51], s59 offen sc1
  buffer_load_dwordx4 v[236:239], v13, s[48:51], s59 offen sc1
  s_waitcnt vmcnt(27)
  s_add_u32 s59, s58, 45056
  v_mfma_f32_16x16x32_bf16 v[16:19], v[172:175], v[128:131], v[16:19]
  v_mfma_f32_16x16x32_bf16 v[36:39], v[172:175], v[132:135], v[36:39]
  v_mfma_f32_16x16x32_bf16 v[56:59], v[172:175], v[136:139], v[56:59]
  v_mfma_f32_16x16x32_bf16 v[76:79], v[172:175], v[140:143], v[76:79]
  buffer_load_dwordx4 v[172:175], v5, s[52:55], s59 offen
  v_mfma_f32_16x16x32_bf16 v[20:23], v[176:179], v[128:131], v[20:23]
  v_mfma_f32_16x16x32_bf16 v[40:43], v[176:179], v[132:135], v[40:43]
  v_mfma_f32_16x16x32_bf16 v[60:63], v[176:179], v[136:139], v[60:63]
  v_mfma_f32_16x16x32_bf16 v[80:83], v[176:179], v[140:143], v[80:83]
  buffer_load_dwordx4 v[176:179], v6, s[52:55], s59 offen
  v_mfma_f32_16x16x32_bf16 v[24:27], v[180:183], v[128:131], v[24:27]
  v_mfma_f32_16x16x32_bf16 v[44:47], v[180:183], v[132:135], v[44:47]
  v_mfma_f32_16x16x32_bf16 v[64:67], v[180:183], v[136:139], v[64:67]
  v_mfma_f32_16x16x32_bf16 v[84:87], v[180:183], v[140:143], v[84:87]
  buffer_load_dwordx4 v[180:183], v7, s[52:55], s59 offen
  v_mfma_f32_16x16x32_bf16 v[28:31], v[184:187], v[128:131], v[28:31]
  v_mfma_f32_16x16x32_bf16 v[48:51], v[184:187], v[132:135], v[48:51]
  v_mfma_f32_16x16x32_bf16 v[68:71], v[184:187], v[136:139], v[68:71]
  v_mfma_f32_16x16x32_bf16 v[88:91], v[184:187], v[140:143], v[88:91]
  buffer_load_dwordx4 v[184:187], v9, s[52:55], s59 offen
  v_mfma_f32_16x16x32_bf16 v[32:35], v[188:191], v[128:131], v[32:35]
  v_mfma_f32_16x16x32_bf16 v[52:55], v[188:191], v[132:135], v[52:55]
  v_mfma_f32_16x16x32_bf16 v[72:75], v[188:191], v[136:139], v[72:75]
  v_mfma_f32_16x16x32_bf16 v[92:95], v[188:191], v[140:143], v[92:95]
  buffer_load_dwordx4 v[188:191], v14, s[52:55], s59 offen
  buffer_load_dwordx4 v[128:131], v10, s[48:51], s59 offen sc1
  buffer_load_dwordx4 v[132:135], v11, s[48:51], s59 offen sc1
  buffer_load_dwordx4 v[136:139], v12, s[48:51], s59 offen sc1
  buffer_load_dwordx4 v[140:143], v13, s[48:51], s59 offen sc1
  s_waitcnt vmcnt(27)
  s_add_u32 s59, s58, 49152
  v_mfma_f32_16x16x32_bf16 v[16:19], v[96:99], v[192:195], v[16:19]
  v_mfma_f32_16x16x32_bf16 v[36:39], v[96:99], v[196:199], v[36:39]
  v_mfma_f32_16x16x32_bf16 v[56:59], v[96:99], v[200:203], v[56:59]
  v_mfma_f32_16x16x32_bf16 v[76:79], v[96:99], v[204:207], v[76:79]
  buffer_load_dwordx4 v[96:99], v5, s[52:55], s59 offen
  v_mfma_f32_16x16x32_bf16 v[20:23], v[100:103], v[192:195], v[20:23]
  v_mfma_f32_16x16x32_bf16 v[40:43], v[100:103], v[196:199], v[40:43]
  v_mfma_f32_16x16x32_bf16 v[60:63], v[100:103], v[200:203], v[60:63]
  v_mfma_f32_16x16x32_bf16 v[80:83], v[100:103], v[204:207], v[80:83]
  buffer_load_dwordx4 v[100:103], v6, s[52:55], s59 offen
  v_mfma_f32_16x16x32_bf16 v[24:27], v[104:107], v[192:195], v[24:27]
  v_mfma_f32_16x16x32_bf16 v[44:47], v[104:107], v[196:199], v[44:47]
  v_mfma_f32_16x16x32_bf16 v[64:67], v[104:107], v[200:203], v[64:67]
  v_mfma_f32_16x16x32_bf16 v[84:87], v[104:107], v[204:207], v[84:87]
  buffer_load_dwordx4 v[104:107], v7, s[52:55], s59 offen
  v_mfma_f32_16x16x32_bf16 v[28:31], v[108:111], v[192:195], v[28:31]
  v_mfma_f32_16x16x32_bf16 v[48:51], v[108:111], v[196:199], v[48:51]
  v_mfma_f32_16x16x32_bf16 v[68:71], v[108:111], v[200:203], v[68:71]
  v_mfma_f32_16x16x32_bf16 v[88:91], v[108:111], v[204:207], v[88:91]
  buffer_load_dwordx4 v[108:111], v9, s[52:55], s59 offen
  v_mfma_f32_16x16x32_bf16 v[32:35], v[112:115], v[192:195], v[32:35]
  v_mfma_f32_16x16x32_bf16 v[52:55], v[112:115], v[196:199], v[52:55]
  v_mfma_f32_16x16x32_bf16 v[72:75], v[112:115], v[200:203], v[72:75]
  v_mfma_f32_16x16x32_bf16 v[92:95], v[112:115], v[204:207], v[92:95]
  buffer_load_dwordx4 v[112:115], v14, s[52:55], s59 offen
  buffer_load_dwordx4 v[192:195], v10, s[48:51], s59 offen sc1
  buffer_load_dwordx4 v[196:199], v11, s[48:51], s59 offen sc1
  buffer_load_dwordx4 v[200:203], v12, s[48:51], s59 offen sc1
  buffer_load_dwordx4 v[204:207], v13, s[48:51], s59 offen sc1
  s_waitcnt vmcnt(27)
  s_add_u32 s59, s3, 52
  s_lshl_b32 s47, s59, 10
  s_cmp_lt_u32 s59, 54
  s_cselect_b32 s59, s47, 2130706432
  v_mfma_f32_16x16x32_bf16 v[16:19], v[116:119], v[208:211], v[16:19]
  v_mfma_f32_16x16x32_bf16 v[36:39], v[116:119], v[212:215], v[36:39]
  v_mfma_f32_16x16x32_bf16 v[56:59], v[116:119], v[216:219], v[56:59]
  v_mfma_f32_16x16x32_bf16 v[76:79], v[116:119], v[220:223], v[76:79]
  buffer_load_dwordx4 v[116:119], v5, s[52:55], s59 offen
  v_mfma_f32_16x16x32_bf16 v[20:23], v[120:123], v[208:211], v[20:23]
  v_mfma_f32_16x16x32_bf16 v[40:43], v[120:123], v[212:215], v[40:43]
  v_mfma_f32_16x16x32_bf16 v[60:63], v[120:123], v[216:219], v[60:63]
  v_mfma_f32_16x16x32_bf16 v[80:83], v[120:123], v[220:223], v[80:83]
  buffer_load_dwordx4 v[120:123], v6, s[52:55], s59 offen
  v_mfma_f32_16x16x32_bf16 v[24:27], v[124:127], v[208:211], v[24:27]
  v_mfma_f32_16x16x32_bf16 v[44:47], v[124:127], v[212:215], v[44:47]
  v_mfma_f32_16x16x32_bf16 v[64:67], v[124:127], v[216:219], v[64:67]
  v_mfma_f32_16x16x32_bf16 v[84:87], v[124:127], v[220:223], v[84:87]
  buffer_load_dwordx4 v[124:127], v7, s[52:55], s59 offen
  v_mfma_f32_16x16x32_bf16 v[28:31], v[144:147], v[208:211], v[28:31]
  v_mfma_f32_16x16x32_bf16 v[48:51], v[144:147], v[212:215], v[48:51]
  v_mfma_f32_16x16x32_bf16 v[68:71], v[144:147], v[216:219], v[68:71]
  v_mfma_f32_16x16x32_bf16 v[88:91], v[144:147], v[220:223], v[88:91]
  buffer_load_dwordx4 v[144:147], v9, s[52:55], s59 offen
  v_mfma_f32_16x16x32_bf16 v[32:35], v[148:151], v[208:211], v[32:35]
  v_mfma_f32_16x16x32_bf16 v[52:55], v[148:151], v[212:215], v[52:55]
  v_mfma_f32_16x16x32_bf16 v[72:75], v[148:151], v[216:219], v[72:75]
  v_mfma_f32_16x16x32_bf16 v[92:95], v[148:151], v[220:223], v[92:95]
  buffer_load_dwordx4 v[148:151], v14, s[52:55], s59 offen
  buffer_load_dwordx4 v[208:211], v10, s[48:51], s59 offen sc1
  buffer_load_dwordx4 v[212:215], v11, s[48:51], s59 offen sc1
  buffer_load_dwordx4 v[216:219], v12, s[48:51], s59 offen sc1
  buffer_load_dwordx4 v[220:223], v13, s[48:51], s59 offen sc1
  s_waitcnt vmcnt(27)
  v_mfma_f32_16x16x32_bf16 v[16:19], v[152:155], v[224:227], v[16:19]
  v_mfma_f32_16x16x32_bf16 v[36:39], v[152:155], v[228:231], v[36:39]
  v_mfma_f32_16x16x32_bf16 v[56:59], v[152:155], v[232:235], v[56:59]
  v_mfma_f32_16x16x32_bf16 v[76:79], v[152:155], v[236:239], v[76:79]
  v_mfma_f32_16x16x32_bf16 v[20:23], v[156:159], v[224:227], v[20:23]
  v_mfma_f32_16x16x32_bf16 v[40:43], v[156:159], v[228:231], v[40:43]
  v_mfma_f32_16x16x32_bf16 v[60:63], v[156:159], v[232:235], v[60:63]
  v_mfma_f32_16x16x32_bf16 v[80:83], v[156:159], v[236:239], v[80:83]
  v_mfma_f32_16x16x32_bf16 v[24:27], v[160:163], v[224:227], v[24:27]
  v_mfma_f32_16x16x32_bf16 v[44:47], v[160:163], v[228:231], v[44:47]
  v_mfma_f32_16x16x32_bf16 v[64:67], v[160:163], v[232:235], v[64:67]
  v_mfma_f32_16x16x32_bf16 v[84:87], v[160:163], v[236:239], v[84:87]
  v_mfma_f32_16x16x32_bf16 v[28:31], v[164:167], v[224:227], v[28:31]
  v_mfma_f32_16x16x32_bf16 v[48:51], v[164:167], v[228:231], v[48:51]
  v_mfma_f32_16x16x32_bf16 v[68:71], v[164:167], v[232:235], v[68:71]
  v_mfma_f32_16x16x32_bf16 v[88:91], v[164:167], v[236:239], v[88:91]
  v_mfma_f32_16x16x32_bf16 v[32:35], v[168:171], v[224:227], v[32:35]
  v_mfma_f32_16x16x32_bf16 v[52:55], v[168:171], v[228:231], v[52:55]
  v_mfma_f32_16x16x32_bf16 v[72:75], v[168:171], v[232:235], v[72:75]
  v_mfma_f32_16x16x32_bf16 v[92:95], v[168:171], v[236:239], v[92:95]
  s_waitcnt vmcnt(18)
  v_mfma_f32_16x16x32_bf16 v[16:19], v[172:175], v[128:131], v[16:19]
  v_mfma_f32_16x16x32_bf16 v[36:39], v[172:175], v[132:135], v[36:39]
  v_mfma_f32_16x16x32_bf16 v[56:59], v[172:175], v[136:139], v[56:59]
  v_mfma_f32_16x16x32_bf16 v[76:79], v[172:175], v[140:143], v[76:79]
  v_mfma_f32_16x16x32_bf16 v[20:23], v[176:179], v[128:131], v[20:23]
  v_mfma_f32_16x16x32_bf16 v[40:43], v[176:179], v[132:135], v[40:43]
  v_mfma_f32_16x16x32_bf16 v[60:63], v[176:179], v[136:139], v[60:63]
  v_mfma_f32_16x16x32_bf16 v[80:83], v[176:179], v[140:143], v[80:83]
  v_mfma_f32_16x16x32_bf16 v[24:27], v[180:183], v[128:131], v[24:27]
  v_mfma_f32_16x16x32_bf16 v[44:47], v[180:183], v[132:135], v[44:47]
  v_mfma_f32_16x16x32_bf16 v[64:67], v[180:183], v[136:139], v[64:67]
  v_mfma_f32_16x16x32_bf16 v[84:87], v[180:183], v[140:143], v[84:87]
  v_mfma_f32_16x16x32_bf16 v[28:31], v[184:187], v[128:131], v[28:31]
  v_mfma_f32_16x16x32_bf16 v[48:51], v[184:187], v[132:135], v[48:51]
  v_mfma_f32_16x16x32_bf16 v[68:71], v[184:187], v[136:139], v[68:71]
  v_mfma_f32_16x16x32_bf16 v[88:91], v[184:187], v[140:143], v[88:91]
  v_mfma_f32_16x16x32_bf16 v[32:35], v[188:191], v[128:131], v[32:35]
  v_mfma_f32_16x16x32_bf16 v[52:55], v[188:191], v[132:135], v[52:55]
  v_mfma_f32_16x16x32_bf16 v[72:75], v[188:191], v[136:139], v[72:75]
  v_mfma_f32_16x16x32_bf16 v[92:95], v[188:191], v[140:143], v[92:95]
  s_waitcnt vmcnt(9)
  v_mfma_f32_16x16x32_bf16 v[16:19], v[96:99], v[192:195], v[16:19]
  v_mfma_f32_16x16x32_bf16 v[36:39], v[96:99], v[196:199], v[36:39]
  v_mfma_f32_16x16x32_bf16 v[56:59], v[96:99], v[200:203], v[56:59]
  v_mfma_f32_16x16x32_bf16 v[76:79], v[96:99], v[204:207], v[76:79]
  v_mfma_f32_16x16x32_bf16 v[20:23], v[100:103], v[192:195], v[20:23]
  v_mfma_f32_16x16x32_bf16 v[40:43], v[100:103], v[196:199], v[40:43]
  v_mfma_f32_16x16x32_bf16 v[60:63], v[100:103], v[200:203], v[60:63]
  v_mfma_f32_16x16x32_bf16 v[80:83], v[100:103], v[204:207], v[80:83]
  v_mfma_f32_16x16x32_bf16 v[24:27], v[104:107], v[192:195], v[24:27]
  v_mfma_f32_16x16x32_bf16 v[44:47], v[104:107], v[196:199], v[44:47]
  v_mfma_f32_16x16x32_bf16 v[64:67], v[104:107], v[200:203], v[64:67]
  v_mfma_f32_16x16x32_bf16 v[84:87], v[104:107], v[204:207], v[84:87]
  v_mfma_f32_16x16x32_bf16 v[28:31], v[108:111], v[192:195], v[28:31]
  v_mfma_f32_16x16x32_bf16 v[48:51], v[108:111], v[196:199], v[48:51]
  v_mfma_f32_16x16x32_bf16 v[68:71], v[108:111], v[200:203], v[68:71]
  v_mfma_f32_16x16x32_bf16 v[88:91], v[108:111], v[204:207], v[88:91]
  v_mfma_f32_16x16x32_bf16 v[32:35], v[112:115], v[192:195], v[32:35]
  v_mfma_f32_16x16x32_bf16 v[52:55], v[112:115], v[196:199], v[52:55]
  v_mfma_f32_16x16x32_bf16 v[72:75], v[112:115], v[200:203], v[72:75]
  v_mfma_f32_16x16x32_bf16 v[92:95], v[112:115], v[204:207], v[92:95]
  s_waitcnt vmcnt(0)
  v_mfma_f32_16x16x32_bf16 v[16:19], v[116:119], v[208:211], v[16:19]
  v_mfma_f32_16x16x32_bf16 v[36:39], v[116:119], v[212:215], v[36:39]
  v_mfma_f32_16x16x32_bf16 v[56:59], v[116:119], v[216:219], v[56:59]
  v_mfma_f32_16x16x32_bf16 v[76:79], v[116:119], v[220:223], v[76:79]
  v_mfma_f32_16x16x32_bf16 v[20:23], v[120:123], v[208:211], v[20:23]
  v_mfma_f32_16x16x32_bf16 v[40:43], v[120:123], v[212:215], v[40:43]
  v_mfma_f32_16x16x32_bf16 v[60:63], v[120:123], v[216:219], v[60:63]
  v_mfma_f32_16x16x32_bf16 v[80:83], v[120:123], v[220:223], v[80:83]
  v_mfma_f32_16x16x32_bf16 v[24:27], v[124:127], v[208:211], v[24:27]
  v_mfma_f32_16x16x32_bf16 v[44:47], v[124:127], v[212:215], v[44:47]
  v_mfma_f32_16x16x32_bf16 v[64:67], v[124:127], v[216:219], v[64:67]
  v_mfma_f32_16x16x32_bf16 v[84:87], v[124:127], v[220:223], v[84:87]
  v_mfma_f32_16x16x32_bf16 v[28:31], v[144:147], v[208:211], v[28:31]
  v_mfma_f32_16x16x32_bf16 v[48:51], v[144:147], v[212:215], v[48:51]
  v_mfma_f32_16x16x32_bf16 v[68:71], v[144:147], v[216:219], v[68:71]
  v_mfma_f32_16x16x32_bf16 v[88:91], v[144:147], v[220:223], v[88:91]
  v_mfma_f32_16x16x32_bf16 v[32:35], v[148:151], v[208:211], v[32:35]
  v_mfma_f32_16x16x32_bf16 v[52:55], v[148:151], v[212:215], v[52:55]
  v_mfma_f32_16x16x32_bf16 v[72:75], v[148:151], v[216:219], v[72:75]
  v_mfma_f32_16x16x32_bf16 v[92:95], v[148:151], v[220:223], v[92:95]
  s_setprio 2
  s_setprio 0
  s_add_u32 s52, s4, 2457600
  s_addc_u32 s53, s5, 0
  s_mov_b32 s54, 819200
  s_mov_b32 s55, 0x20000
  s_mul_i32 s46, s45, 20480
  v_add_u32 v10, s46, v3
  s_add_u32 s59, s3, 16
  s_lshl_b32 s59, s59, 10
  buffer_load_dwordx4 v[176:179], v10, s[52:55], s59 offen
  v_add_u32 v10, 20480, v10
  buffer_load_dwordx4 v[180:183], v10, s[52:55], s59 offen
  v_add_u32 v10, 20480, v10
  buffer_load_dwordx4 v[184:187], v10, s[52:55], s59 offen
  v_add_u32 v10, 20480, v10
  buffer_load_dwordx4 v[188:191], v10, s[52:55], s59 offen
  v_add_u32 v10, 20480, v10
  buffer_load_dwordx4 v[192:195], v10, s[52:55], s59 offen
  s_add_u32 s48, s4, 15646720
  s_addc_u32 s49, s5, 0
  s_mov_b32 s50, 2621440
  s_mov_b32 s51, 0x20000
  s_add_u32 s46, s3, 0
  s_and_b32 s46, s46, 3
  s_lshl_b32 s47, s40, 2
  s_add_u32 s46, s46, s47
  s_mul_i32 s46, s46, 20480
  v_add_u32 v6, s46, v3
  s_add_u32 s46, s3, 1
  s_and_b32 s46, s46, 3
  s_lshl_b32 s47, s40, 2
  s_add_u32 s46, s46, s47
  s_mul_i32 s46, s46, 20480
  v_add_u32 v7, s46, v3
  s_add_u32 s46, s3, 2
  s_and_b32 s46, s46, 3
  s_lshl_b32 s47, s40, 2
  s_add_u32 s46, s46, s47
  s_mul_i32 s46, s46, 20480
  v_add_u32 v8, s46, v3
  s_add_u32 s46, s3, 3
  s_and_b32 s46, s46, 3
  s_lshl_b32 s47, s40, 2
  s_add_u32 s46, s46, s47
  s_mul_i32 s46, s46, 20480
  v_add_u32 v9, s46, v3
  s_mul_i32 s46, s3, 20480
  v_add_u32 v14, s46, v3
  ds_read_b128 v[196:199], v14 offset:0
  ds_read_b128 v[200:203], v14 offset:1024
  ds_read_b128 v[204:207], v14 offset:2048
  ds_read_b128 v[208:211], v14 offset:3072
  ds_read_b128 v[212:215], v14 offset:4096
  s_lshl_b32 s46, s40, 5
  s_add_u32 s46, s46, 2048
  v_and_b32 v4, 7, v2
  v_lshlrev_b32 v4, 2, v4
  s_mov_b32 s47, 400000
main_kernel_poll41:
  buffer_load_dword v253, v4, s[28:31], s46 offen sc1
  s_waitcnt vmcnt(0)
  v_cmp_ne_u32 vcc, 1, v253
  s_cmp_eq_u64 vcc, 0
  s_cbranch_scc1 main_kernel_pdone42
  s_sub_u32 s47, s47, 1
  s_cmp_lg_u32 s47, 0
  s_cbranch_scc1 main_kernel_poll41
main_kernel_pdone42:
  s_setprio 2
  s_add_u32 s59, s3, 16
  s_lshl_b32 s59, s59, 10
  buffer_load_dwordx4 v[160:163], v6, s[48:51], s59 offen sc1
  buffer_load_dwordx4 v[164:167], v7, s[48:51], s59 offen sc1
  buffer_load_dwordx4 v[168:171], v8, s[48:51], s59 offen sc1
  buffer_load_dwordx4 v[172:175], v9, s[48:51], s59 offen sc1
  s_add_u32 s59, s3, 0
  s_lshl_b32 s59, s59, 10
  buffer_load_dwordx4 v[96:99], v6, s[48:51], s59 offen sc1
  buffer_load_dwordx4 v[100:103], v7, s[48:51], s59 offen sc1
  buffer_load_dwordx4 v[104:107], v8, s[48:51], s59 offen sc1
  buffer_load_dwordx4 v[108:111], v9, s[48:51], s59 offen sc1
  s_add_u32 s59, s3, 4
  s_lshl_b32 s59, s59, 10
  buffer_load_dwordx4 v[112:115], v6, s[48:51], s59 offen sc1
  buffer_load_dwordx4 v[116:119], v7, s[48:51], s59 offen sc1
  buffer_load_dwordx4 v[120:123], v8, s[48:51], s59 offen sc1
  buffer_load_dwordx4 v[124:127], v9, s[48:51], s59 offen sc1
  s_add_u32 s59, s3, 8
  s_lshl_b32 s59, s59, 10
  buffer_load_dwordx4 v[128:131], v6, s[48:51], s59 offen sc1
  buffer_load_dwordx4 v[132:135], v7, s[48:51], s59 offen sc1
  buffer_load_dwordx4 v[136:139], v8, s[48:51], s59 offen sc1
  buffer_load_dwordx4 v[140:143], v9, s[48:51], s59 offen sc1
  s_add_u32 s59, s3, 12
  s_lshl_b32 s59, s59, 10
  buffer_load_dwordx4 v[144:147], v6, s[48:51], s59 offen sc1
  buffer_load_dwordx4 v[148:151], v7, s[48:51], s59 offen sc1
  buffer_load_dwordx4 v[152:155], v8, s[48:51], s59 offen sc1
  buffer_load_dwordx4 v[156:159], v9, s[48:51], s59 offen sc1
  s_waitcnt vmcnt(16)
  v_mfma_f32_16x16x32_bf16 v[16:19], v[176:179], v[160:163], v[16:19]
  v_mfma_f32_16x16x32_bf16 v[36:39], v[176:179], v[164:167], v[36:39]
  v_mfma_f32_16x16x32_bf16 v[56:59], v[176:179], v[168:171], v[56:59]
  v_mfma_f32_16x16x32_bf16 v[76:79], v[176:179], v[172:175], v[76:79]
  v_mfma_f32_16x16x32_bf16 v[20:23], v[180:183], v[160:163], v[20:23]
  v_mfma_f32_16x16x32_bf16 v[40:43], v[180:183], v[164:167], v[40:43]
  v_mfma_f32_16x16x32_bf16 v[60:63], v[180:183], v[168:171], v[60:63]
  v_mfma_f32_16x16x32_bf16 v[80:83], v[180:183], v[172:175], v[80:83]
  v_mfma_f32_16x16x32_bf16 v[24:27], v[184:187], v[160:163], v[24:27]
  v_mfma_f32_16x16x32_bf16 v[44:47], v[184:187], v[164:167], v[44:47]
  v_mfma_f32_16x16x32_bf16 v[64:67], v[184:187], v[168:171], v[64:67]
  v_mfma_f32_16x16x32_bf16 v[84:87], v[184:187], v[172:175], v[84:87]
  v_mfma_f32_16x16x32_bf16 v[28:31], v[188:191], v[160:163], v[28:31]
  v_mfma_f32_16x16x32_bf16 v[48:51], v[188:191], v[164:167], v[48:51]
  v_mfma_f32_16x16x32_bf16 v[68:71], v[188:191], v[168:171], v[68:71]
  v_mfma_f32_16x16x32_bf16 v[88:91], v[188:191], v[172:175], v[88:91]
  v_mfma_f32_16x16x32_bf16 v[32:35], v[192:195], v[160:163], v[32:35]
  v_mfma_f32_16x16x32_bf16 v[52:55], v[192:195], v[164:167], v[52:55]
  v_mfma_f32_16x16x32_bf16 v[72:75], v[192:195], v[168:171], v[72:75]
  v_mfma_f32_16x16x32_bf16 v[92:95], v[192:195], v[172:175], v[92:95]
  s_waitcnt vmcnt(12)
  s_waitcnt lgkmcnt(0)
  v_mfma_f32_16x16x32_bf16 v[16:19], v[196:199], v[96:99], v[16:19]
  v_mfma_f32_16x16x32_bf16 v[36:39], v[196:199], v[100:103], v[36:39]
  v_mfma_f32_16x16x32_bf16 v[56:59], v[196:199], v[104:107], v[56:59]
  v_mfma_f32_16x16x32_bf16 v[76:79], v[196:199], v[108:111], v[76:79]
  ds_read_b128 v[216:219], v14 offset:5120
  v_mfma_f32_16x16x32_bf16 v[20:23], v[200:203], v[96:99], v[20:23]
  v_mfma_f32_16x16x32_bf16 v[40:43], v[200:203], v[100:103], v[40:43]
  v_mfma_f32_16x16x32_bf16 v[60:63], v[200:203], v[104:107], v[60:63]
  v_mfma_f32_16x16x32_bf16 v[80:83], v[200:203], v[108:111], v[80:83]
  ds_read_b128 v[220:223], v14 offset:6144
  v_mfma_f32_16x16x32_bf16 v[24:27], v[204:207], v[96:99], v[24:27]
  v_mfma_f32_16x16x32_bf16 v[44:47], v[204:207], v[100:103], v[44:47]
  v_mfma_f32_16x16x32_bf16 v[64:67], v[204:207], v[104:107], v[64:67]
  v_mfma_f32_16x16x32_bf16 v[84:87], v[204:207], v[108:111], v[84:87]
  ds_read_b128 v[224:227], v14 offset:7168
  v_mfma_f32_16x16x32_bf16 v[28:31], v[208:211], v[96:99], v[28:31]
  v_mfma_f32_16x16x32_bf16 v[48:51], v[208:211], v[100:103], v[48:51]
  v_mfma_f32_16x16x32_bf16 v[68:71], v[208:211], v[104:107], v[68:71]
  v_mfma_f32_16x16x32_bf16 v[88:91], v[208:211], v[108:111], v[88:91]
  ds_read_b128 v[228:231], v14 offset:8192
  v_mfma_f32_16x16x32_bf16 v[32:35], v[212:215], v[96:99], v[32:35]
  v_mfma_f32_16x16x32_bf16 v[52:55], v[212:215], v[100:103], v[52:55]
  v_mfma_f32_16x16x32_bf16 v[72:75], v[212:215], v[104:107], v[72:75]
  v_mfma_f32_16x16x32_bf16 v[92:95], v[212:215], v[108:111], v[92:95]
  ds_read_b128 v[232:235], v14 offset:9216
  s_waitcnt vmcnt(8)
  s_waitcnt lgkmcnt(0)
  v_mfma_f32_16x16x32_bf16 v[16:19], v[216:219], v[112:115], v[16:19]
  v_mfma_f32_16x16x32_bf16 v[36:39], v[216:219], v[116:119], v[36:39]
  v_mfma_f32_16x16x32_bf16 v[56:59], v[216:219], v[120:123], v[56:59]
  v_mfma_f32_16x16x32_bf16 v[76:79], v[216:219], v[124:127], v[76:79]
  ds_read_b128 v[196:199], v14 offset:10240
  v_mfma_f32_16x16x32_bf16 v[20:23], v[220:223], v[112:115], v[20:23]
  v_mfma_f32_16x16x32_bf16 v[40:43], v[220:223], v[116:119], v[40:43]
  v_mfma_f32_16x16x32_bf16 v[60:63], v[220:223], v[120:123], v[60:63]
  v_mfma_f32_16x16x32_bf16 v[80:83], v[220:223], v[124:127], v[80:83]
  ds_read_b128 v[200:203], v14 offset:11264
  v_mfma_f32_16x16x32_bf16 v[24:27], v[224:227], v[112:115], v[24:27]
  v_mfma_f32_16x16x32_bf16 v[44:47], v[224:227], v[116:119], v[44:47]
  v_mfma_f32_16x16x32_bf16 v[64:67], v[224:227], v[120:123], v[64:67]
  v_mfma_f32_16x16x32_bf16 v[84:87], v[224:227], v[124:127], v[84:87]
  ds_read_b128 v[204:207], v14 offset:12288
  v_mfma_f32_16x16x32_bf16 v[28:31], v[228:231], v[112:115], v[28:31]
  v_mfma_f32_16x16x32_bf16 v[48:51], v[228:231], v[116:119], v[48:51]
  v_mfma_f32_16x16x32_bf16 v[68:71], v[228:231], v[120:123], v[68:71]
  v_mfma_f32_16x16x32_bf16 v[88:91], v[228:231], v[124:127], v[88:91]
  ds_read_b128 v[208:211], v14 offset:13312
  v_mfma_f32_16x16x32_bf16 v[32:35], v[232:235], v[112:115], v[32:35]
  v_mfma_f32_16x16x32_bf16 v[52:55], v[232:235], v[116:119], v[52:55]
  v_mfma_f32_16x16x32_bf16 v[72:75], v[232:235], v[120:123], v[72:75]
  v_mfma_f32_16x16x32_bf16 v[92:95], v[232:235], v[124:127], v[92:95]
  ds_read_b128 v[212:215], v14 offset:14336
  s_waitcnt vmcnt(4)
  s_waitcnt lgkmcnt(0)
  v_mfma_f32_16x16x32_bf16 v[16:19], v[196:199], v[128:131], v[16:19]
  v_mfma_f32_16x16x32_bf16 v[36:39], v[196:199], v[132:135], v[36:39]
  v_mfma_f32_16x16x32_bf16 v[56:59], v[196:199], v[136:139], v[56:59]
  v_mfma_f32_16x16x32_bf16 v[76:79], v[196:199], v[140:143], v[76:79]
  ds_read_b128 v[216:219], v14 offset:15360
  v_mfma_f32_16x16x32_bf16 v[20:23], v[200:203], v[128:131], v[20:23]
  v_mfma_f32_16x16x32_bf16 v[40:43], v[200:203], v[132:135], v[40:43]
  v_mfma_f32_16x16x32_bf16 v[60:63], v[200:203], v[136:139], v[60:63]
  v_mfma_f32_16x16x32_bf16 v[80:83], v[200:203], v[140:143], v[80:83]
  ds_read_b128 v[220:223], v14 offset:16384
  v_mfma_f32_16x16x32_bf16 v[24:27], v[204:207], v[128:131], v[24:27]
  v_mfma_f32_16x16x32_bf16 v[44:47], v[204:207], v[132:135], v[44:47]
  v_mfma_f32_16x16x32_bf16 v[64:67], v[204:207], v[136:139], v[64:67]
  v_mfma_f32_16x16x32_bf16 v[84:87], v[204:207], v[140:143], v[84:87]
  ds_read_b128 v[224:227], v14 offset:17408
  v_mfma_f32_16x16x32_bf16 v[28:31], v[208:211], v[128:131], v[28:31]
  v_mfma_f32_16x16x32_bf16 v[48:51], v[208:211], v[132:135], v[48:51]
  v_mfma_f32_16x16x32_bf16 v[68:71], v[208:211], v[136:139], v[68:71]
  v_mfma_f32_16x16x32_bf16 v[88:91], v[208:211], v[140:143], v[88:91]
  ds_read_b128 v[228:231], v14 offset:18432
  v_mfma_f32_16x16x32_bf16 v[32:35], v[212:215], v[128:131], v[32:35]
  v_mfma_f32_16x16x32_bf16 v[52:55], v[212:215], v[132:135], v[52:55]
  v_mfma_f32_16x16x32_bf16 v[72:75], v[212:215], v[136:139], v[72:75]
  v_mfma_f32_16x16x32_bf16 v[92:95], v[212:215], v[140:143], v[92:95]
  ds_read_b128 v[232:235], v14 offset:19456
  s_waitcnt vmcnt(0)
  s_waitcnt lgkmcnt(0)
  v_mfma_f32_16x16x32_bf16 v[16:19], v[216:219], v[144:147], v[16:19]
  v_mfma_f32_16x16x32_bf16 v[36:39], v[216:219], v[148:151], v[36:39]
  v_mfma_f32_16x16x32_bf16 v[56:59], v[216:219], v[152:155], v[56:59]
  v_mfma_f32_16x16x32_bf16 v[76:79], v[216:219], v[156:159], v[76:79]
  v_mfma_f32_16x16x32_bf16 v[20:23], v[220:223], v[144:147], v[20:23]
  v_mfma_f32_16x16x32_bf16 v[40:43], v[220:223], v[148:151], v[40:43]
  v_mfma_f32_16x16x32_bf16 v[60:63], v[220:223], v[152:155], v[60:63]
  v_mfma_f32_16x16x32_bf16 v[80:83], v[220:223], v[156:159], v[80:83]
  v_mfma_f32_16x16x32_bf16 v[24:27], v[224:227], v[144:147], v[24:27]
  v_mfma_f32_16x16x32_bf16 v[44:47], v[224:227], v[148:151], v[44:47]
  v_mfma_f32_16x16x32_bf16 v[64:67], v[224:227], v[152:155], v[64:67]
  v_mfma_f32_16x16x32_bf16 v[84:87], v[224:227], v[156:159], v[84:87]
  v_mfma_f32_16x16x32_bf16 v[28:31], v[228:231], v[144:147], v[28:31]
  v_mfma_f32_16x16x32_bf16 v[48:51], v[228:231], v[148:151], v[48:51]
  v_mfma_f32_16x16x32_bf16 v[68:71], v[228:231], v[152:155], v[68:71]
  v_mfma_f32_16x16x32_bf16 v[88:91], v[228:231], v[156:159], v[88:91]
  v_mfma_f32_16x16x32_bf16 v[32:35], v[232:235], v[144:147], v[32:35]
  v_mfma_f32_16x16x32_bf16 v[52:55], v[232:235], v[148:151], v[52:55]
  v_mfma_f32_16x16x32_bf16 v[72:75], v[232:235], v[152:155], v[72:75]
  v_mfma_f32_16x16x32_bf16 v[92:95], v[232:235], v[156:159], v[92:95]
  s_barrier
  s_add_u32 s46, s3, 1
  s_and_b32 s46, s46, 3
  s_mul_i32 s46, s46, 15360
  s_add_u32 s46, s46, 0
  v_add_u32 v4, s46, v3
  ds_write_b128 v4, v[36:39] offset:0
  ds_write_b128 v4, v[40:43] offset:1024
  ds_write_b128 v4, v[44:47] offset:2048
  ds_write_b128 v4, v[48:51] offset:3072
  ds_write_b128 v4, v[52:55] offset:4096
  s_add_u32 s46, s3, 2
  s_and_b32 s46, s46, 3
  s_mul_i32 s46, s46, 15360
  s_add_u32 s46, s46, 5120
  v_add_u32 v4, s46, v3
  ds_write_b128 v4, v[56:59] offset:0
  ds_write_b128 v4, v[60:63] offset:1024
  ds_write_b128 v4, v[64:67] offset:2048
  ds_write_b128 v4, v[68:71] offset:3072
  ds_write_b128 v4, v[72:75] offset:4096
  s_add_u32 s46, s3, 3
  s_and_b32 s46, s46, 3
  s_mul_i32 s46, s46, 15360
  s_add_u32 s46, s46, 10240
  v_add_u32 v4, s46, v3
  ds_write_b128 v4, v[76:79] offset:0
  ds_write_b128 v4, v[80:83] offset:1024
  ds_write_b128 v4, v[84:87] offset:2048
  ds_write_b128 v4, v[88:91] offset:3072
  ds_write_b128 v4, v[92:95] offset:4096
  s_mov_b32 s72, s6
  s_mov_b32 s73, s7
  s_mov_b32 s74, 2621440
  s_mov_b32 s75, 0x20000
  s_lshl_b32 s47, s70, 4
  v_and_b32 v14, 15, v2
  v_add_u32 v14, s47, v14
  v_mul_u32_u24 v12, 1280, v14
  v_lshrrev_b32 v13, 4, v2
  v_lshlrev_b32 v13, 3, v13
  v_add_u32 v12, v12, v13
  s_lshl_b32 s71, s45, 5
  v_lshlrev_b32 v120, 16, v240
  v_and_b32 v121, 0xffff0000, v240
  v_lshlrev_b32 v122, 16, v241
  v_and_b32 v123, 0xffff0000, v241
  v_lshlrev_b32 v124, 16, v242
  v_and_b32 v125, 0xffff0000, v242
  v_lshlrev_b32 v126, 16, v243
  v_and_b32 v127, 0xffff0000, v243
  v_lshlrev_b32 v128, 16, v244
  v_and_b32 v129, 0xffff0000, v244
  v_lshlrev_b32 v130, 16, v245
  v_and_b32 v131, 0xffff0000, v245
  v_lshlrev_b32 v132, 16, v246
  v_and_b32 v133, 0xffff0000, v246
  v_lshlrev_b32 v134, 16, v247
  v_and_b32 v135, 0xffff0000, v247
  v_lshlrev_b32 v136, 16, v248
  v_and_b32 v137, 0xffff0000, v248
  v_lshlrev_b32 v138, 16, v249
  v_and_b32 v139, 0xffff0000, v249
  s_mul_i32 s46, s3, 15360
  v_add_u32 v5, s46, v3
  s_waitcnt lgkmcnt(0)
  s_barrier
  ds_read_b128 v[36:39], v5 offset:0
  ds_read_b128 v[40:43], v5 offset:1024
  ds_read_b128 v[44:47], v5 offset:2048
  ds_read_b128 v[48:51], v5 offset:3072
  ds_read_b128 v[52:55], v5 offset:4096
  ds_read_b128 v[56:59], v5 offset:5120
  ds_read_b128 v[60:63], v5 offset:6144
  ds_read_b128 v[64:67], v5 offset:7168
  ds_read_b128 v[68:71], v5 offset:8192
  ds_read_b128 v[72:75], v5 offset:9216
  ds_read_b128 v[76:79], v5 offset:10240
  ds_read_b128 v[80:83], v5 offset:11264
  ds_read_b128 v[84:87], v5 offset:12288
  ds_read_b128 v[88:91], v5 offset:13312
  ds_read_b128 v[92:95], v5 offset:14336
  s_waitcnt lgkmcnt(10)
  v_pk_add_f32 v[16:17], v[16:17], v[36:37]
  v_pk_add_f32 v[18:19], v[18:19], v[38:39]
  v_pk_add_f32 v[20:21], v[20:21], v[40:41]
  v_pk_add_f32 v[22:23], v[22:23], v[42:43]
  v_pk_add_f32 v[24:25], v[24:25], v[44:45]
  v_pk_add_f32 v[26:27], v[26:27], v[46:47]
  v_pk_add_f32 v[28:29], v[28:29], v[48:49]
  v_pk_add_f32 v[30:31], v[30:31], v[50:51]
  v_pk_add_f32 v[32:33], v[32:33], v[52:53]
  v_pk_add_f32 v[34:35], v[34:35], v[54:55]
  s_waitcnt lgkmcnt(5)
  v_pk_add_f32 v[16:17], v[16:17], v[56:57]
  v_pk_add_f32 v[18:19], v[18:19], v[58:59]
  v_pk_add_f32 v[20:21], v[20:21], v[60:61]
  v_pk_add_f32 v[22:23], v[22:23], v[62:63]
  v_pk_add_f32 v[24:25], v[24:25], v[64:65]
  v_pk_add_f32 v[26:27], v[26:27], v[66:67]
  v_pk_add_f32 v[28:29], v[28:29], v[68:69]
  v_pk_add_f32 v[30:31], v[30:31], v[70:71]
  v_pk_add_f32 v[32:33], v[32:33], v[72:73]
  v_pk_add_f32 v[34:35], v[34:35], v[74:75]
  s_waitcnt lgkmcnt(0)
  v_pk_add_f32 v[16:17], v[16:17], v[76:77]
  v_pk_add_f32 v[18:19], v[18:19], v[78:79]
  v_pk_add_f32 v[20:21], v[20:21], v[80:81]
  v_pk_add_f32 v[22:23], v[22:23], v[82:83]
  v_pk_add_f32 v[24:25], v[24:25], v[84:85]
  v_pk_add_f32 v[26:27], v[26:27], v[86:87]
  v_pk_add_f32 v[28:29], v[28:29], v[88:89]
  v_pk_add_f32 v[30:31], v[30:31], v[90:91]
  v_pk_add_f32 v[32:33], v[32:33], v[92:93]
  v_pk_add_f32 v[34:35], v[34:35], v[94:95]
  v_pk_fma_f32 v[16:17], v[250:251], v[120:121], v[16:17] op_sel:[0,0,0] op_sel_hi:[0,1,1]
  v_pk_fma_f32 v[18:19], v[250:251], v[122:123], v[18:19] op_sel:[0,0,0] op_sel_hi:[0,1,1]
  v_pk_fma_f32 v[20:21], v[250:251], v[124:125], v[20:21] op_sel:[0,0,0] op_sel_hi:[0,1,1]
  v_pk_fma_f32 v[22:23], v[250:251], v[126:127], v[22:23] op_sel:[0,0,0] op_sel_hi:[0,1,1]
  v_pk_fma_f32 v[24:25], v[250:251], v[128:129], v[24:25] op_sel:[0,0,0] op_sel_hi:[0,1,1]
  v_pk_fma_f32 v[26:27], v[250:251], v[130:131], v[26:27] op_sel:[0,0,0] op_sel_hi:[0,1,1]
  v_pk_fma_f32 v[28:29], v[250:251], v[132:133], v[28:29] op_sel:[0,0,0] op_sel_hi:[0,1,1]
  v_pk_fma_f32 v[30:31], v[250:251], v[134:135], v[30:31] op_sel:[0,0,0] op_sel_hi:[0,1,1]
  v_pk_fma_f32 v[32:33], v[250:251], v[136:137], v[32:33] op_sel:[0,0,0] op_sel_hi:[0,1,1]
  v_pk_fma_f32 v[34:35], v[250:251], v[138:139], v[34:35] op_sel:[0,0,0] op_sel_hi:[0,1,1]
  v_cvt_pk_bf16_f32 v96, v16, v17
  v_cvt_pk_bf16_f32 v97, v18, v19
  v_cvt_pk_bf16_f32 v98, v20, v21
  v_cvt_pk_bf16_f32 v99, v22, v23
  v_cvt_pk_bf16_f32 v100, v24, v25
  v_cvt_pk_bf16_f32 v101, v26, v27
  v_cvt_pk_bf16_f32 v102, v28, v29
  v_cvt_pk_bf16_f32 v103, v30, v31
  v_cvt_pk_bf16_f32 v104, v32, v33
  v_cvt_pk_bf16_f32 v105, v34, v35
  v_lshrrev_b32 v13, 4, v2
  v_and_b32 v9, 1, v13
  v_lshlrev_b32 v9, 5, v9
  v_lshrrev_b32 v13, 1, v13
  v_lshlrev_b32 v13, 4, v13
  v_mul_u32_u24 v10, 1280, v14
  v_add3_u32 v10, v10, v9, v13
  v_permlane16_swap_b32 v96, v98
  v_permlane16_swap_b32 v97, v99
  buffer_store_dwordx4 v[96:99], v10, s[72:75], s71 offen offset:0
  v_permlane16_swap_b32 v100, v102
  v_permlane16_swap_b32 v101, v103
  buffer_store_dwordx4 v[100:103], v10, s[72:75], s71 offen offset:64
  buffer_store_dwordx2 v[104:105], v12, s[72:75], s71 offen offset:128
main_kernel_end:
  s_endpgm
code_end:
.p2align 6
.type korder_table,@object
korder_table:
.long 0, 8, 16, 24, 4, 4, 4, 4
.long 32, 40, 48, 56, 4, 4, 4, 4
.long 80, 88, 96, 104, 4, 4, 4, 4
.long 112, 120, 128, 136, 4, 4, 4, 4
.long 64, 144, 72, 152, 4, 4, 4, 4
.long 160, 168, 176, 184, 4, 4, 4, 4
.long 192, 200, 208, 216, 4, 4, 4, 4
.long 240, 248, 256, 264, 4, 4, 4, 4
.long 272, 280, 288, 296, 4, 4, 4, 4
.long 224, 304, 232, 312, 4, 4, 4, 4
.long 320, 328, 336, 344, 4, 4, 4, 4
.long 352, 360, 368, 376, 4, 4, 4, 4
.long 400, 408, 416, 424, 4, 4, 4, 4
.long 432, 440, 448, 456, 4, 4, 4, 4
.long 384, 464, 392, 472, 4, 4, 4, 4
.long 480, 488, 496, 504, 4, 4, 4, 4
.long 512, 520, 528, 536, 4, 4, 4, 4
.long 560, 568, 576, 584, 4, 4, 4, 4
.long 592, 600, 608, 616, 4, 4, 4, 4
.long 544, 624, 552, 632, 4, 4, 4, 4
.long 0, 8, 16, 24, 4, 4, 4, 4
.long 32, 40, 48, 56, 4, 4, 4, 4
.long 64, 72, 80, 88, 4, 4, 4, 4
.long 96, 104, 112, 120, 4, 4, 4, 4
.long 128, 136, 144, 152, 4, 4, 4, 4
.long 176, 184, 192, 200, 4, 4, 4, 4
.long 160, 208, 168, 216, 4, 4, 4, 4
.long 224, 232, 240, 248, 4, 4, 4, 4
.long 256, 264, 272, 280, 4, 4, 4, 4
.long 288, 296, 304, 312, 4, 4, 4, 4
.long 320, 328, 336, 344, 4, 4, 4, 4
.long 352, 360, 368, 376, 4, 4, 4, 4
.long 400, 408, 416, 424, 4, 4, 4, 4
.long 384, 432, 392, 440, 4, 4, 4, 4
.long 448, 456, 464, 472, 4, 4, 4, 4
.long 480, 488, 496, 504, 4, 4, 4, 4
.long 512, 520, 528, 536, 4, 4, 4, 4
.long 544, 552, 560, 568, 4, 4, 4, 4
.long 576, 584, 592, 600, 4, 4, 4, 4
.long 624, 632, 640, 648, 4, 4, 4, 4
.long 608, 656, 616, 664, 4, 4, 4, 4
.long 672, 680, 688, 696, 4, 4, 4, 4
.long 704, 712, 720, 728, 4, 4, 4, 4
.long 736, 744, 752, 760, 4, 4, 4, 4
.long 768, 776, 784, 792, 4, 4, 4, 4
.long 800, 808, 816, 824, 4, 4, 4, 4
.long 848, 856, 864, 872, 4, 4, 4, 4
.long 832, 880, 840, 888, 4, 4, 4, 4
.long 896, 904, 912, 920, 4, 4, 4, 4
.long 928, 936, 944, 952, 4, 4, 4, 4
.long 960, 968, 976, 984, 4, 4, 4, 4
.long 992, 1000, 1008, 1016, 4, 4, 4, 4
.long 1024, 1032, 1040, 1048, 4, 4, 4, 4
.long 1072, 1080, 1088, 1096, 4, 4, 4, 4
.long 1056, 1104, 1064, 1112, 4, 4, 4, 4
.long 1120, 1128, 1136, 1144, 4, 4, 4, 4
.long 1152, 1160, 1168, 1176, 4, 4, 4, 4
.long 1184, 1192, 1200, 1208, 4, 4, 4, 4
.long 1216, 1224, 1232, 1240, 4, 4, 4, 4
.long 1248, 1256, 1264, 1272, 4, 4, 4, 4
.long 1296, 1304, 1312, 1320, 4, 4, 4, 4
.long 1280, 1328, 1288, 1336, 4, 4, 4, 4
.long 1344, 1352, 1360, 1368, 4, 4, 4, 4
.long 1392, 1400, 1408, 1416, 4, 4, 4, 4
.long 1440, 1448, 1456, 1464, 4, 4, 4, 4
.long 1488, 1496, 1504, 1512, 4, 4, 4, 4
.long 1376, 1424, 1384, 1432, 4, 4, 4, 4
.long 1472, 1520, 1480, 1528, 4, 4, 4, 4
.long 1536, 1544, 1552, 1560, 4, 4, 4, 4
.long 1584, 1592, 1600, 1608, 4, 4, 4, 4
.long 1632, 1640, 1648, 1656, 4, 4, 4, 4
.long 1680, 1688, 1696, 1704, 4, 4, 4, 4
.long 1568, 1616, 1576, 1624, 4, 4, 4, 4
.long 1664, 1712, 1672, 1720, 4, 4, 4, 4
.long 0, 20, 8, 28, 4, 4, 4, 4
.long 40, 60, 48, 68, 4, 4, 4, 4
.long 80, 100, 88, 108, 4, 4, 4, 4
.long 120, 140, 128, 148, 4, 4, 4, 4
.long 160, 180, 168, 188, 4, 4, 4, 4
.long 200, 220, 208, 228, 4, 4, 4, 4
.long 240, 260, 248, 268, 4, 4, 4, 4
.long 280, 300, 288, 308, 4, 4, 4, 4
.long 320, 340, 328, 348, 4, 4, 4, 4
.long 360, 380, 368, 388, 4, 4, 4, 4
.long 400, 420, 408, 428, 4, 4, 4, 4
.long 440, 460, 448, 468, 4, 4, 4, 4
.long 480, 500, 488, 508, 4, 4, 4, 4
.long 520, 540, 528, 548, 4, 4, 4, 4
.long 560, 580, 568, 588, 4, 4, 4, 4
.long 600, 620, 608, 628, 4, 4, 4, 4
.long 16, 96, 36, 116, 40, 40, 40, 40
.long 176, 256, 196, 276, 40, 40, 40, 40
.long 336, 416, 356, 436, 40, 40, 40, 40
.long 496, 576, 516, 596, 40, 40, 40, 40
.size korder_table, 3008
.section .rodata,"a"
.p2align 6
.amdhsa_kernel front_kernel
  .amdhsa_next_free_vgpr 224
  .amdhsa_next_free_sgpr 102
  .amdhsa_accum_offset 224
  .amdhsa_group_segment_fixed_size 0
  .amdhsa_kernarg_size 112
  .amdhsa_user_sgpr_count 2
  .amdhsa_user_sgpr_kernarg_segment_ptr 1
  .amdhsa_system_sgpr_workgroup_id_x 1
  .amdhsa_float_denorm_mode_32 3
.end_amdhsa_kernel
.p2align 6
.amdhsa_kernel main_kernel
  .amdhsa_next_free_vgpr 256
  .amdhsa_next_free_sgpr 102
  .amdhsa_accum_offset 256
  .amdhsa_group_segment_fixed_size 0
  .amdhsa_kernarg_size 112
  .amdhsa_user_sgpr_count 2
  .amdhsa_user_sgpr_kernarg_segment_ptr 1
  .amdhsa_system_sgpr_workgroup_id_x 1
  .amdhsa_float_denorm_mode_32 3
.end_amdhsa_kernel
```
